```python
import torch

def _softmax(x, axis=-1):
    return torch.softmax(x, dim=axis)
def _gelu(x):
    return torch.nn.functional.gelu(x, approximate="tanh")
def _silu(x):
    return torch.nn.functional.silu(x)
def _sigmoid(x):
    return torch.sigmoid(x)
def _layernorm(x, axis=-1, eps=1e-5):
    m = x.mean(dim=axis, keepdim=True)
    v = x.var(dim=axis, keepdim=True, unbiased=False)
    return (x - m) / torch.sqrt(v + eps)
def _scatter_add(tgt, idx, src, axis=0):
    return tgt.clone().index_add_(axis, idx, src)
def _segment_sum(src, seg, n):
    out = torch.zeros((n,) + src.shape[1:], dtype=src.dtype)
    return out.index_add_(0, seg, src)
def _pad(x, pw):
    flat = tuple(v for pair in reversed(pw) for v in pair)
    return torch.nn.functional.pad(x, flat)

kernel_name = 'gated_mix__sliding_block__ssm_conv_h3__prompt'

def setup_inputs():

    _w = (lambda a: (lambda t: t.to(torch.bfloat16) if t.is_floating_point() else t)(torch.as_tensor(a)))
    def _A_setup():
        B, S, D = 1, 2048, 512
        return {
            "x": _w((lambda *s: torch.randn(*s, dtype=torch.bfloat16) * 0.05)(B, S, D)),
            "wqkv": _w((lambda *s: torch.randn(*s, dtype=torch.bfloat16) * 0.8)(D, 3 * D)),
            "wo": _w((lambda *s: torch.randn(*s, dtype=torch.bfloat16) * 0.05)(D, D)),
        }
    _A_in = _A_setup()

    def _B_setup():
        B, S, D = 1, 2048, 512
        ks = 4
        return {
            "q": _w((lambda *s: torch.randn(*s, dtype=torch.bfloat16) * 0.05)(B, S, D)),
            "k": _w((lambda *s: torch.randn(*s, dtype=torch.bfloat16) * 0.8)(B, S, D)),
            "v": _w((lambda *s: torch.randn(*s, dtype=torch.bfloat16) * 0.8)(B, S, D)),
            "shift_k": _w((lambda *s: torch.randn(*s, dtype=torch.bfloat16) * 0.8)(D, ks) * 0.5),
            "ssm_k": _w((lambda *s: torch.randn(*s, dtype=torch.bfloat16) * 1.6)(D, S) * (1.0 / S ** 0.5)),
            "ssm_D": _w((lambda *s: torch.randn(*s, dtype=torch.bfloat16) * 0.8)(D)),
        }
    _B_in = _B_setup()

    return {
        "A_x": _A_in["x"],
        "A_wqkv": _A_in["wqkv"],
        "A_wo": _A_in["wo"],
        "B_q": _B_in["q"],
        "B_k": _B_in["k"],
        "B_v": _B_in["v"],
        "B_shift_k": _B_in["shift_k"],
        "B_ssm_k": _B_in["ssm_k"],
        "B_ssm_D": _B_in["ssm_D"],
        "gate_w": _w((lambda *s: torch.randn(*s, dtype=torch.bfloat16) * 0.05)(512) * 16.0),
    }

def reference(A_x, A_wqkv, A_wo, B_q, B_k, B_v, B_shift_k, B_ssm_k, B_ssm_D, gate_w):
    def _A_ref(x, wqkv, wo):
        B, S, D = x.shape
        H = 32; Dh = D // H; W = 256
        qkv = (lambda x, *d: x.permute(*d))((x @ wqkv).reshape(B, S, 3, H, Dh), 2, 0, 3, 1, 4)
        q, k, v = qkv[0], qkv[1], qkv[2]
        scores = torch.einsum("bhqd,bhkd->bhqk", q, k) * (Dh ** -0.5)
        idx = torch.arange(S)
        mask = (idx[:, None] - idx[None, :] >= 0) & (idx[:, None] - idx[None, :] < W)
        scores = torch.where(mask[None, None], scores, -1e9)
        p = _softmax(scores, axis=-1)
        o = torch.einsum("bhqk,bhkd->bhqd", p, v)
        return (lambda x, *d: x.permute(*d))(o, 0, 2, 1, 3).reshape(B, S, D) @ wo

    def _B_ref(q, k, v, shift_k, ssm_k, ssm_D):
        B, S, D = q.shape
        ks = shift_k.shape[-1]
        k_pad = _pad(k, ((0, 0), (ks - 1, 0), (0, 0)))
        k_shift = torch.zeros_like(k)
        for t in range(ks):
            k_shift = k_shift + k_pad[:, t:t + S, :] * shift_k[:, ks - 1 - t][None, None, :]
        kv = k_shift * v
        L = 2 * S
        kv_pad = _pad(kv, ((0, 0), (0, S), (0, 0)))
        kf_pad = _pad(ssm_k, ((0, 0), (0, S)))
        kv_f = (lambda x, axes=(-2,-1): torch.fft.rfft2(x.float(), dim=axes))(kv_pad[:, None, :, :], axes=(1, 2))
        kf_f = (lambda x, axes=(-2,-1): torch.fft.rfft2(x.float(), dim=axes))(kf_pad[:, None, :], axes=(1, 2))
        kf_f = (lambda x, *d: x.permute(*d))(kf_f, 1, 2, 0)
        y_f = kv_f * kf_f[None, :, :, :]
        y = (lambda x, s, axes=(-2,-1): torch.fft.irfft2(x, s=s, dim=axes).to(torch.bfloat16))(y_f, (1, L), axes=(1, 2))[:, 0, :S, :]
        y = y + kv * ssm_D[None, None, :]
        return q * y

    x = A_x
    g = _sigmoid((x * gate_w).sum(-1, keepdims=True))
    a = _A_ref(x, A_wqkv, A_wo)
    b = _B_ref(x, B_k, B_v, B_shift_k, B_ssm_k, B_ssm_D)
    return g * a + (1 - g) * b
```

```asm
; @launch grid=(256,1,1) block=(512,1,1) lds=163840
.amdgcn_target "amdgcn-amd-amdhsa--gfx950"
.text
.globl gated_mix__sliding_block__ssm_conv_h3__prompt_kernel
.p2align 8
.type gated_mix__sliding_block__ssm_conv_h3__prompt_kernel,@function
gated_mix__sliding_block__ssm_conv_h3__prompt_kernel:
    s_cmp_ge_u32 s2, 256
    s_cbranch_scc1 L_END
    s_load_dwordx16 s[64:79], s[0:1], 0
    s_load_dwordx8 s[80:87], s[0:1], 64
    s_load_dwordx2 s[88:89], s[0:1], 96
    s_memrealtime s[46:47]
    v_lshrrev_b32 v3, 6, v0
    v_and_b32 v1, 63, v0
    v_readfirstlane_b32 s36, v3
    v_mov_b32 v2, 0
    s_add_u32 s39, s2, 0
    s_and_b32 s39, s39, 7
    s_lshr_b32 s40, s2, 3
    s_lshl_b32 s37, s39, 2
    s_lshr_b32 s44, s2, 6
    s_add_u32 s37, s37, s44
    s_and_b32 s38, s40, 7
    s_add_u32 s100, s38, 4
    s_and_b32 s100, s100, 7
    s_add_u32 s90, s38, s39
    s_mul_i32 s44, s44, 0
    s_cmp_eq_u32 s38, 3
    s_cselect_b32 s44, s44, 0
    s_add_u32 s90, s90, s44
    s_and_b32 s90, s90, 7
    v_lshrrev_b32 v8, 3, v1
    v_and_b32 v9, 7, v1
    v_lshlrev_b32 v211, 4, v1
    s_getpc_b64 s[92:93]
L_PC:
    s_lshl_b32 s44, s40, 3
    s_add_u32 s44, s44, s36
    s_lshl_b32 s44, s44, 7
    s_min_u32 s44, s44, L_SLOW-L_PC
    v_mov_b32 v3, s44
    global_load_dword v3, v3, s[92:93]
    s_cmp_ge_u32 s36, 4
    s_cbranch_scc1 L_LOADER
    v_lshlrev_b32 v10, 10, v8
    v_lshl_add_u32 v10, v9, 4, v10
    s_lshl_b32 s44, s40, 16
    s_lshl_b32 s45, s39, 7
    s_add_u32 s44, s44, s45
    v_add_u32 v10, s44, v10
    v_subrev_u32 v11, 8192, v10
    v_and_b32 v14, 15, v1
    s_lshl_b32 s44, s39, 6
    s_lshl_b32 s45, s36, 4
    s_add_u32 s50, s44, s45
    v_add_u32 v15, s50, v9
    v_lshlrev_b32 v12, 3, v15
    s_lshl_b32 s45, s36, 14
    s_lshl_b32 s24, s36, 11
    s_add_u32 m0, s24, 147456
    s_add_u32 s49, s45, 8192
    s_mul_i32 s48, s40, 8
    v_add_u32 v19, s48, v1
    v_lshrrev_b32 v20, 1, v19
    s_add_u32 s48, s39, 4
    s_lshl_b32 s48, s48, 6
    v_add_u32 v20, s48, v20
    v_and_b32 v20, 511, v20
    v_mul_u32_u24 v20, 3072, v20
    v_and_b32 v19, 1, v19
    v_lshl_add_u32 v19, v19, 10, v20
    v_add_u32 v19, 1408, v19
    s_waitcnt lgkmcnt(0)
    s_cmp_lg_u32 s36, 3
    s_cbranch_scc1 L_NOTLB
    s_cmp_gt_u32 s40, 16
    s_cbranch_scc1 L_NOTLB
    s_mov_b32 s44, m0
    s_min_u32 s48, s40, 12
    s_lshl_b32 m0, s48, 1
    s_sub_u32 s48, s40, 9
    s_movrels_b64 s[92:93], s[64:65]
    s_lshl_b32 s48, s48, 21
    s_cmp_ge_u32 s40, 12
    s_cselect_b32 s48, s48, 0
    v_mov_b32 v20, s48
    s_mov_b32 m0, s44
    global_load_dword v3, v20, s[92:93]
L_NOTLB:
    s_cmp_lg_u32 s36, 2
    s_cbranch_scc1 L_NOP3
    s_mov_b64 exec, 255
    global_load_dword v3, v19, s[66:67]
    s_mov_b64 exec, -1
L_NOP3:
    s_mov_b32 s16, s72
    s_and_b32 s17, s73, 0xffff
    s_mov_b32 s18, 2097152
    s_mov_b32 s19, 0x20000
    buffer_load_dwordx4 v10, s[16:19], s45 offen lds
    s_add_u32 m0, s24, 148480
    s_mov_b32 s20, s74
    s_and_b32 s21, s75, 0xffff
    s_mov_b32 s22, 2097152
    s_mov_b32 s23, 0x20000
    buffer_load_dwordx4 v10, s[16:19], s49 offen lds
    s_add_u32 m0, s24, 155648
    s_nop 0
    buffer_load_dwordx4 v10, s[20:23], s45 offen lds
    s_add_u32 m0, s24, 156672
    s_cmp_eq_u32 s36, 2
    buffer_load_dwordx4 v10, s[20:23], s49 offen lds
    s_cbranch_scc0 L_PFA
    s_mov_b32 m0, 146432
    s_nop 0
    buffer_load_dwordx4 v11, s[16:19], 0 offen lds
L_PFA:
    global_load_dwordx2 v[132:133], v12, s[76:77]
    global_load_dwordx2 v[134:135], v12, s[76:77] offset:64
    s_cmp_eq_u32 s36, 0
    s_cbranch_scc0 L_PFB
    s_cmp_ge_u32 s2, 8
    s_cbranch_scc1 L_PFB
    s_or_b32 s46, s46, 1
    v_mov_b32 v24, s46
    v_mov_b32 v25, s47
    v_mov_b32 v26, 0
    v_mov_b32 v27, 0
    s_mov_b64 exec, 1
    global_atomic_cmpswap_x2 v26, v[24:27], s[86:87] sc1
    s_mov_b64 exec, -1
L_PFB:
    s_cmp_eq_u32 s36, 1
    s_cbranch_scc0 L_PFC
    s_lshl_b32 s45, s90, 7
    v_add_u32 v22, s45, v211
    v_and_b32 v22, 1023, v22
    s_mov_b32 m0, 141824
    s_nop 0
    global_load_lds_dwordx4 v22, s[82:83]
L_PFC:
    s_barrier
    s_and_b32 s4, s36, 1
    s_lshr_b32 s5, s36, 1
    s_mov_b32 s28, s88
    s_and_b32 s29, s89, 0xffff
    s_mov_b32 s30, 16777216
    s_mov_b32 s31, 0x20000
    s_mov_b32 s8, s66
    s_and_b32 s9, s67, 0xffff
    s_mov_b32 s10, 1572864
    s_mov_b32 s11, 0x20000
    v_and_b32 v16, 31, v1
    v_mov_b32 v248, 0
    v_lshrrev_b32 v23, 5, v1
    v_lshrrev_b32 v34, 4, v16
    v_mul_u32_u24 v34, 6144, v34
    v_lshl_add_u32 v34, v14, 7, v34
    s_mul_i32 s45, s5, 12288
    v_add_u32 v34, s45, v34
    v_lshrrev_b32 v35, 1, v14
    v_xor_b32 v35, v35, v23
    v_xor_b32 v36, 0, v35
    v_lshl_add_u32 v200, v36, 4, v34
    v_add_u32 v204, 49152, v200
    v_xor_b32 v36, 2, v35
    v_lshl_add_u32 v201, v36, 4, v34
    v_add_u32 v205, 49152, v201
    v_xor_b32 v36, 4, v35
    v_lshl_add_u32 v202, v36, 4, v34
    v_add_u32 v206, 49152, v202
    v_xor_b32 v36, 6, v35
    v_lshl_add_u32 v203, v36, 4, v34
    v_add_u32 v207, 49152, v203
    v_lshrrev_b32 v36, 2, v1
    v_and_b32 v36, 3, v36
    v_lshrrev_b32 v37, 1, v36
    v_xor_b32 v37, s4, v37
    v_lshlrev_b32 v37, 6, v37
    v_lshl_add_u32 v37, v36, 7, v37
    v_lshrrev_b32 v28, 4, v1
    v_and_b32 v29, 1, v28
    v_lshl_add_u32 v37, v29, 5, v37
    v_and_b32 v30, 3, v1
    v_lshl_add_u32 v37, v30, 3, v37
    v_lshl_add_u32 v210, v23, 10, v37
    v_lshl_add_u32 v37, v23, 11, v37
    v_add_u32 v208, 2048, v37
    v_add_u32 v209, 51200, v37
    v_lshl_add_u32 v37, v28, 3, v36
    v_lshrrev_b32 v13, 1, v30
    v_lshl_add_u32 v37, v13, 5, v37
    v_lshlrev_b32 v37, 7, v37
    v_and_b32 v13, 1, v1
    v_lshl_add_u32 v37, v13, 3, v37
    s_lshl_b32 s45, s36, 5
    s_add_u32 s45, s45, 146432
    v_add_u32 v137, s45, v37
    v_lshlrev_b32 v12, 12, v15
    v_and_b32 v13, 1, v8
    v_lshl_add_u32 v13, v13, 2, v28
    v_lshlrev_b32 v13, 4, v13
    v_sub_u32 v12, v12, v13
    v_add_u32 v136, 112, v12
    s_lshl_b32 s45, s40, 7
    s_sub_u32 s25, 6295424, s45
    v_lshlrev_b32 v31, 2, v29
    v_xor_b32 v31, v9, v31
    v_mul_u32_u24 v244, 3072, v8
    v_lshl_add_u32 v244, v31, 4, v244
    s_lshl_b32 s44, s39, 18
    s_lshl_b32 s45, s40, 13
    s_add_u32 s44, s44, s45
    s_add_u32 s44, s44, s24
    v_add_u32 v22, s44, v211
    s_lshr_b32 s45, s36, 1
    s_mul_i32 s45, s45, 4224
    s_add_u32 s45, s45, s24
    s_add_u32 m0, s45, 98368
    s_nop 0
    global_load_lds_dwordx4 v22, s[78:79]
    global_load_lds_dwordx4 v22, s[78:79] offset:1024
    v_min_u32 v19, 47, v1
    v_lshlrev_b32 v19, 10, v19
    s_mul_i32 s48, s40, 49152
    s_add_u32 s48, s48, 384
    v_add_u32 v19, s48, v19
    v_and_b32 v20, 1, v8
    v_mul_u32_u24 v20, 3072, v20
    v_lshl_add_u32 v20, v9, 7, v20
    s_mul_i32 s48, s2, 6144
    v_add_u32 v20, s48, v20
    s_cmp_eq_u32 s36, 2
    s_cselect_b64 vcc, -1, 0
    v_cndmask_b32 v19, v19, v20, vcc
    s_lshl_b32 s48, s2, 11
    v_lshl_add_u32 v20, v14, 7, s48
    s_lshl_b32 s48, s40, 14
    s_add_u32 s48, s48, 384
    v_lshl_add_u32 v21, v14, 10, s48
    v_cmp_gt_u32 vcc, 32, v1
    s_cmp_eq_u32 s36, 1
    s_cselect_b32 s48, s68, s66
    s_cselect_b32 s49, s69, s67
    v_cndmask_b32 v20, v20, v21, vcc
    s_cselect_b64 vcc, -1, 0
    v_cndmask_b32 v19, v19, v20, vcc
    s_bitcmp1_b32 6, s36
    s_cselect_b64 exec, -1, 1
    global_load_dword v249, v19, s[48:49]
    s_mov_b64 exec, -1
    s_and_b32 s53, s36, 3
    s_lshr_b32 s54, s36, 2
    s_mov_b32 s60, 0x0000ffff
    s_mov_b32 s61, 0x0000ffff
    v_and_b32 v253, 15, v1
    v_lshlrev_b32 v253, 4, v253
    v_lshrrev_b32 v38, 5, v1
    v_lshl_add_u32 v253, v38, 8, v253
    v_add_u32 v253, 1024, v253
    s_lshl_b32 s45, s53, 12
    s_add_u32 s45, s45, 81920
    v_add_u32 v252, s45, v211
    v_lshrrev_b32 v254, 3, v1
    v_lshlrev_b32 v254, 10, v254
    v_lshrrev_b32 v38, 2, v1
    v_and_b32 v7, 3, v38
    v_and_b32 v38, 4, v38
    v_and_b32 v39, 7, v1
    v_xor_b32 v38, v38, v39
    v_lshl_add_u32 v254, v38, 4, v254
    s_lshl_b32 s48, s53, 11
    s_mul_i32 s45, s53, 768
    s_add_u32 s45, s45, 65536
    v_mov_b32 v255, s45
    s_max_u32 s45, s37, 1
    s_sub_u32 s45, s45, 1
    v_min_u32 v7, s45, v7
    v_sub_u32 v7, 3, v7
    v_lshlrev_b32 v7, 5, v7
    v_and_b32 v39, 3, v1
    v_lshl_add_u32 v7, v39, 3, v7
    s_lshl_b32 s49, s38, 5
    s_add_u32 s49, s49, s37
    s_lshl_b32 s45, s49, 5
    s_add_u32 s56, s45, 10747776
    s_lshl_b32 s94, s49, 14
    s_add_u32 s94, s94, s48
    s_add_u32 s94, s94, 12582912
    s_lshl_b32 s3, s37, 14
    s_sub_u32 s3, s94, s3
    s_lshl_b32 s55, s37, 1
    s_sub_u32 s55, 8, s55
    s_max_i32 s55, s55, 0
    s_lshl_b32 s57, s37, 3
    s_add_u32 s57, s57, s38
    s_lshl_b32 s57, s57, 3
    s_add_u32 s57, s57, s36
    s_lshl_b32 s57, s57, 10
    s_add_u32 s57, s57, 6291456
    s_lshl_b32 s58, s37, 10
    s_add_u32 s58, s58, 10518528
    s_add_u32 s95, s58, 64
    s_lshl_b32 s49, s38, 4
    s_add_u32 s49, s49, s36
    s_lshl_b32 s49, s49, 3
    s_add_u32 s93, s49, s58
    s_and_b32 s92, s57, 0xffff
    s_add_u32 s92, s92, 98304
    s_lshl_b32 s62, s36, 16
    s_lshl_b32 s45, s100, 7
    s_add_u32 s62, s62, s45
    s_lshl_b32 s63, s36, 13
    s_mov_b32 s12, s68
    s_and_b32 s13, s69, 0xffff
    s_mov_b32 s14, 524288
    s_mov_b32 s15, 0x20000
    v_mov_b32 v38, 0
    v_mov_b32 v39, 0xff800000
    s_mov_b32 s48, 0xffffffff
    s_mov_b32 s49, 0xfffffff0
    v_cndmask_b32 v212, v39, v38, s[48:49]
    s_mov_b32 s50, 0xfffffffe
    s_mov_b32 s51, 0xffffffe0
    v_cndmask_b32 v213, v39, v38, s[50:51]
    s_mov_b32 s48, 0xfffffffc
    s_mov_b32 s49, 0xffffffc0
    v_cndmask_b32 v214, v39, v38, s[48:49]
    s_mov_b32 s50, 0xfffffff8
    s_mov_b32 s51, 0xffffff80
    v_cndmask_b32 v215, v39, v38, s[50:51]
    s_mov_b32 s48, 0xffffff00
    s_mov_b32 s49, 0xfffff000
    v_cndmask_b32 v216, v39, v38, s[48:49]
    s_mov_b32 s50, 0xfffffe00
    s_mov_b32 s51, 0xffffe000
    v_cndmask_b32 v217, v39, v38, s[50:51]
    s_mov_b32 s48, 0xfffffc00
    s_mov_b32 s49, 0xffffc000
    v_cndmask_b32 v218, v39, v38, s[48:49]
    s_mov_b32 s50, 0xfffff800
    s_mov_b32 s51, 0xffff8000
    v_cndmask_b32 v219, v39, v38, s[50:51]
    s_mov_b32 s48, 0xffff0000
    s_mov_b32 s49, 0xfff00000
    v_cndmask_b32 v220, v39, v38, s[48:49]
    s_mov_b32 s50, 0xfffe0000
    s_mov_b32 s51, 0xffe00000
    v_cndmask_b32 v221, v39, v38, s[50:51]
    s_mov_b32 s48, 0xfffc0000
    s_mov_b32 s49, 0xffc00000
    v_cndmask_b32 v222, v39, v38, s[48:49]
    s_mov_b32 s50, 0xfff80000
    s_mov_b32 s51, 0xff800000
    v_cndmask_b32 v223, v39, v38, s[50:51]
    s_mov_b32 s48, 0xff000000
    s_mov_b32 s49, 0xf0000000
    v_cndmask_b32 v224, v39, v38, s[48:49]
    s_mov_b32 s50, 0xfe000000
    s_mov_b32 s51, 0xe0000000
    v_cndmask_b32 v225, v39, v38, s[50:51]
    s_mov_b32 s48, 0xfc000000
    s_mov_b32 s49, 0xc0000000
    v_cndmask_b32 v226, v39, v38, s[48:49]
    s_mov_b32 s50, 0xf8000000
    s_mov_b32 s51, 0x80000000
    v_cndmask_b32 v227, v39, v38, s[50:51]
    s_mov_b32 s48, 0x110000
    s_mov_b32 s49, 0x110000
    v_mov_b32 v229, 0x3f803f80
    v_cndmask_b32 v228, 0, v229, s[48:49]
    v_mov_b32 v229, v228
    v_mov_b64 v[230:231], v[228:229]
    v_mov_b64 v[232:233], v[228:229]
    v_mov_b64 v[234:235], v[228:229]
    v_mov_b64 v[236:237], v[228:229]
    v_mov_b64 v[238:239], v[228:229]
    v_mov_b64 v[240:241], v[228:229]
    v_mov_b64 v[242:243], v[228:229]
    v_lshl_add_u32 v245, v29, 11, v253
    s_lshl_b32 s49, s38, 5
    s_add_u32 s49, s49, s37
    s_lshl_b32 s27, s49, 2
    s_add_u32 s27, s27, s36
    s_lshl_b32 s27, s27, 3
    s_add_u32 s27, s27, 10747904
    s_lshl_b32 s45, s5, 13
    s_lshl_b32 s48, s4, 12
    s_add_u32 s45, s45, s48
    s_lshl_b32 s6, s49, 14
    s_add_u32 s6, s6, s45
    s_add_u32 s6, s6, 12582912
    s_add_u32 s49, s45, 81920
    v_add_u32 v4, s49, v211
    v_add_u32 v5, s49, v245
    s_lshr_b32 s45, s45, 1
    s_add_u32 s45, s45, 73728
    v_add_u32 v6, s45, v211
    s_mul_i32 s7, s36, 49152
    s_lshl_b32 s45, s38, 7
    s_add_u32 s7, s7, s45
    s_lshl_b32 s26, s39, 2
    s_add_u32 s26, s26, s36
    s_lshl_b32 s26, s26, 5
    s_add_u32 s26, s26, s40
    s_lshl_b32 s26, s26, 5
    s_add_u32 s26, s26, 10616832
    s_sub_u32 s52, s100, s90
    s_and_b32 s52, s52, 7
    s_lshl_b32 s52, s52, 4
    s_lshl_b32 s45, s4, 3
    s_add_u32 s52, s52, s45
    s_mov_b32 s59, s56
    s_lshl_b32 s45, s5, 7
    s_add_u32 s45, s45, 141312
    v_lshl_add_u32 v250, v16, 2, s45
    v_lshrrev_b32 v12, 5, v1
    v_lshrrev_b32 v13, 2, v1
    v_and_b32 v13, 3, v13
    v_lshrrev_b32 v14, 1, v13
    v_xor_b32 v14, s4, v14
    v_lshlrev_b32 v14, 6, v14
    v_lshl_add_u32 v15, v12, 2, v13
    v_lshl_add_u32 v14, v15, 7, v14
    v_and_b32 v15, 1, v1
    v_lshl_add_u32 v14, v15, 5, v14
    v_lshrrev_b32 v15, 1, v1
    v_and_b32 v15, 1, v15
    v_lshl_add_u32 v14, v15, 3, v14
    v_lshrrev_b32 v15, 4, v1
    v_and_b32 v15, 1, v15
    v_lshl_add_u32 v8, v15, 4, v14
    v_lshl_add_u32 v14, v12, 4, v13
    v_lshlrev_b32 v14, 7, v14
    v_lshl_add_u32 v14, v15, 5, v14
    v_and_b32 v13, 3, v1
    v_lshl_add_u32 v14, v13, 3, v14
    s_lshl_b32 s45, s4, 12
    s_lshl_b32 s48, s5, 6
    s_add_u32 s45, s45, s48
    s_add_u32 s45, s45, 65536
    v_add_u32 v9, s45, v14
    s_lshl_b32 s45, s5, 12
    s_add_u32 s45, s45, 98304
    v_add_u32 v10, s45, v211
    v_and_b32 v13, 15, v1
    v_lshlrev_b32 v13, 10, v13
    v_lshl_add_u32 v13, v12, 5, v13
    v_lshl_add_u32 v11, v15, 4, v13
    s_lshl_b32 s45, s37, 16
    s_lshl_b32 s48, s5, 15
    s_add_u32 s45, s45, s48
    s_lshl_b32 s48, s100, 7
    s_add_u32 s45, s45, s48
    s_lshl_b32 s48, s4, 6
    s_add_u32 s70, s45, s48
    s_add_u32 s71, s70, 16384
    s_lshl_b32 s45, s53, 11
    s_add_u32 s45, s45, 81920
    v_add_u32 v12, s45, v211
    v_add_u32 v13, s45, v253
    s_lshl_b32 s45, s53, 10
    s_add_u32 s45, s45, 73728
    v_add_u32 v14, s45, v211
    s_lshl_b32 s45, s36, 11
    s_add_u32 s45, s45, 115200
    v_add_u32 v251, s45, v211
    ds_write_b128 v251, v[8:11]
    ds_write_b128 v251, v[12:15] offset:1024
    s_waitcnt vmcnt(3) lgkmcnt(0)
    v_alignbit_b32 v138, v132, v132, 16
    v_alignbit_b32 v139, v133, v133, 16
    v_alignbit_b32 v140, v134, v134, 16
    v_alignbit_b32 v141, v135, v135, 16
    s_barrier
    ds_read_b64_tr_b16 v[144:145], v137 offset:512
    ds_read_b64_tr_b16 v[146:147], v137 offset:1024
    ds_read_b64_tr_b16 v[148:149], v137 offset:1536
    ds_read_b64_tr_b16 v[150:151], v137 offset:9216
    ds_read_b64_tr_b16 v[152:153], v137 offset:9728
    ds_read_b64_tr_b16 v[154:155], v137 offset:528
    ds_read_b64_tr_b16 v[156:157], v137 offset:1040
    ds_read_b64_tr_b16 v[158:159], v137 offset:1552
    ds_read_b64_tr_b16 v[160:161], v137 offset:9232
    ds_read_b64_tr_b16 v[162:163], v137 offset:9744
    s_waitcnt lgkmcnt(5)
    v_alignbit_b32 v164, v145, v144, 16
    v_alignbit_b32 v165, v146, v145, 16
    v_alignbit_b32 v166, v147, v146, 16
    v_alignbit_b32 v167, v148, v147, 16
    v_alignbit_b32 v168, v149, v148, 16
    v_dot2_f32_bf16 v184, v165, v138, 0
    v_dot2_f32_bf16 v185, v146, v138, 0
    v_dot2_f32_bf16 v186, v166, v138, 0
    v_dot2_f32_bf16 v187, v147, v138, 0
    v_dot2_f32_bf16 v188, v167, v138, 0
    v_dot2_f32_bf16 v189, v148, v138, 0
    v_dot2_f32_bf16 v190, v168, v138, 0
    v_dot2_f32_bf16 v191, v149, v138, 0
    v_dot2_f32_bf16 v184, v164, v139, v184
    v_dot2_f32_bf16 v185, v145, v139, v185
    v_dot2_f32_bf16 v186, v165, v139, v186
    v_dot2_f32_bf16 v187, v146, v139, v187
    v_dot2_f32_bf16 v188, v166, v139, v188
    v_dot2_f32_bf16 v189, v147, v139, v189
    v_dot2_f32_bf16 v190, v167, v139, v190
    v_dot2_f32_bf16 v191, v148, v139, v191
    v_lshlrev_b32 v176, 16, v150
    v_and_b32 v177, 0xffff0000, v150
    v_lshlrev_b32 v178, 16, v151
    v_and_b32 v179, 0xffff0000, v151
    v_lshlrev_b32 v180, 16, v152
    v_and_b32 v181, 0xffff0000, v152
    v_lshlrev_b32 v182, 16, v153
    v_and_b32 v183, 0xffff0000, v153
    v_pk_mul_f32 v[184:185], v[184:185], v[176:177]
    v_pk_mul_f32 v[186:187], v[186:187], v[178:179]
    v_pk_mul_f32 v[188:189], v[188:189], v[180:181]
    v_pk_mul_f32 v[190:191], v[190:191], v[182:183]
    v_cvt_pk_bf16_f32 v192, v191, v190
    v_cvt_pk_bf16_f32 v193, v189, v188
    v_cvt_pk_bf16_f32 v194, v187, v186
    v_cvt_pk_bf16_f32 v195, v185, v184
    s_waitcnt lgkmcnt(0)
    v_alignbit_b32 v164, v155, v154, 16
    v_alignbit_b32 v165, v156, v155, 16
    v_alignbit_b32 v166, v157, v156, 16
    v_alignbit_b32 v167, v158, v157, 16
    v_alignbit_b32 v168, v159, v158, 16
    v_dot2_f32_bf16 v184, v165, v140, 0
    v_dot2_f32_bf16 v185, v156, v140, 0
    v_dot2_f32_bf16 v186, v166, v140, 0
    v_dot2_f32_bf16 v187, v157, v140, 0
    v_dot2_f32_bf16 v188, v167, v140, 0
    v_dot2_f32_bf16 v189, v158, v140, 0
    v_dot2_f32_bf16 v190, v168, v140, 0
    v_dot2_f32_bf16 v191, v159, v140, 0
    v_dot2_f32_bf16 v184, v164, v141, v184
    v_dot2_f32_bf16 v185, v155, v141, v185
    v_dot2_f32_bf16 v186, v165, v141, v186
    v_dot2_f32_bf16 v187, v156, v141, v187
    v_dot2_f32_bf16 v188, v166, v141, v188
    v_dot2_f32_bf16 v189, v157, v141, v189
    v_dot2_f32_bf16 v190, v167, v141, v190
    v_dot2_f32_bf16 v191, v158, v141, v191
    v_lshlrev_b32 v176, 16, v160
    v_and_b32 v177, 0xffff0000, v160
    v_lshlrev_b32 v178, 16, v161
    v_and_b32 v179, 0xffff0000, v161
    v_lshlrev_b32 v180, 16, v162
    v_and_b32 v181, 0xffff0000, v162
    v_lshlrev_b32 v182, 16, v163
    v_and_b32 v183, 0xffff0000, v163
    v_pk_mul_f32 v[184:185], v[184:185], v[176:177]
    v_pk_mul_f32 v[186:187], v[186:187], v[178:179]
    v_pk_mul_f32 v[188:189], v[188:189], v[180:181]
    v_pk_mul_f32 v[190:191], v[190:191], v[182:183]
    v_cvt_pk_bf16_f32 v196, v191, v190
    v_cvt_pk_bf16_f32 v197, v189, v188
    v_cvt_pk_bf16_f32 v198, v187, v186
    v_cvt_pk_bf16_f32 v199, v185, v184
    s_add_u32 s45, s25, 32768
    buffer_store_dwordx4 v[192:195], v136, s[28:31], s25 offen sc1
    buffer_store_dwordx4 v[196:199], v136, s[28:31], s45 offen sc1
    global_load_dwordx2 v[246:247], v248, s[86:87] sc1
    s_waitcnt vmcnt(4)
    s_barrier
    ds_read_b128 v[72:75], v200 offset:0
    ds_read_b64_tr_b16 v[40:41], v208 offset:0
    ds_read_b64_tr_b16 v[42:43], v208 offset:512
    ds_read_b64_tr_b16 v[44:45], v208 offset:1024
    ds_read_b64_tr_b16 v[46:47], v208 offset:1536
    ds_read_b128 v[76:79], v201 offset:0
    ds_read_b64_tr_b16 v[48:49], v208 offset:6144
    ds_read_b64_tr_b16 v[50:51], v208 offset:6656
    ds_read_b64_tr_b16 v[52:53], v208 offset:7168
    ds_read_b64_tr_b16 v[54:55], v208 offset:7680
    s_waitcnt lgkmcnt(5)
    v_mfma_f32_32x32x16_bf16 v[8:23], v[40:43], v[72:75], 0
    ds_read_b128 v[80:83], v202 offset:0
    ds_read_b64_tr_b16 v[56:57], v208 offset:12288
    ds_read_b64_tr_b16 v[58:59], v208 offset:12800
    v_mfma_f32_32x32x16_bf16 v[24:39], v[72:75], v[44:47], 0
    ds_read_b64_tr_b16 v[60:61], v208 offset:13312
    ds_read_b64_tr_b16 v[62:63], v208 offset:13824
    ds_read_b128 v[84:87], v203 offset:0
    s_waitcnt lgkmcnt(6)
    v_mfma_f32_32x32x16_bf16 v[8:23], v[48:51], v[76:79], v[8:23]
    ds_read_b64_tr_b16 v[64:65], v208 offset:18432
    ds_read_b64_tr_b16 v[66:67], v208 offset:18944
    v_mfma_f32_32x32x16_bf16 v[24:39], v[76:79], v[52:55], v[24:39]
    ds_read_b64_tr_b16 v[68:69], v208 offset:19456
    ds_read_b64_tr_b16 v[70:71], v208 offset:19968
    s_waitcnt lgkmcnt(5)
    v_mfma_f32_32x32x16_bf16 v[8:23], v[56:59], v[80:83], v[8:23]
    v_mfma_f32_32x32x16_bf16 v[24:39], v[80:83], v[60:63], v[24:39]
    s_waitcnt lgkmcnt(0)
    v_mfma_f32_32x32x16_bf16 v[8:23], v[64:67], v[84:87], v[8:23]
    v_mfma_f32_32x32x16_bf16 v[24:39], v[84:87], v[68:71], v[24:39]
    s_barrier
    ds_read_b128 v[88:91], v200 offset:24576
    ds_read_b64_tr_b16 v[40:41], v208 offset:24576
    ds_read_b64_tr_b16 v[42:43], v208 offset:25088
    ds_read_b64_tr_b16 v[44:45], v208 offset:25600
    ds_read_b64_tr_b16 v[46:47], v208 offset:26112
    ds_read_b128 v[92:95], v201 offset:24576
    ds_read_b64_tr_b16 v[48:49], v208 offset:30720
    ds_read_b64_tr_b16 v[50:51], v208 offset:31232
    ds_read_b64_tr_b16 v[52:53], v208 offset:31744
    ds_read_b64_tr_b16 v[54:55], v208 offset:32256
    s_waitcnt lgkmcnt(5)
    v_mfma_f32_32x32x16_bf16 v[8:23], v[40:43], v[88:91], v[8:23]
    ds_read_b128 v[96:99], v202 offset:24576
    ds_read_b64_tr_b16 v[56:57], v208 offset:36864
    ds_read_b64_tr_b16 v[58:59], v208 offset:37376
    v_mfma_f32_32x32x16_bf16 v[24:39], v[88:91], v[44:47], v[24:39]
    ds_read_b64_tr_b16 v[60:61], v208 offset:37888
    ds_read_b64_tr_b16 v[62:63], v208 offset:38400
    ds_read_b128 v[100:103], v203 offset:24576
    s_waitcnt lgkmcnt(6)
    v_mfma_f32_32x32x16_bf16 v[8:23], v[48:51], v[92:95], v[8:23]
    ds_read_b64_tr_b16 v[64:65], v208 offset:43008
    ds_read_b64_tr_b16 v[66:67], v208 offset:43520
    v_mfma_f32_32x32x16_bf16 v[24:39], v[92:95], v[52:55], v[24:39]
    ds_read_b64_tr_b16 v[68:69], v208 offset:44032
    ds_read_b64_tr_b16 v[70:71], v208 offset:44544
    s_waitcnt lgkmcnt(5)
    v_mfma_f32_32x32x16_bf16 v[8:23], v[56:59], v[96:99], v[8:23]
    v_mfma_f32_32x32x16_bf16 v[24:39], v[96:99], v[60:63], v[24:39]
    s_waitcnt vmcnt(0)
    s_mov_b32 s44, 200000
NON_1:
    v_readfirstlane_b32 s42, v246
    v_readfirstlane_b32 s43, v247
    s_cmp_lg_u32 s42, 0
    s_cbranch_scc1 NOND_2
    global_load_dwordx2 v[246:247], v248, s[86:87] sc1
    s_waitcnt vmcnt(0)
    s_sub_u32 s44, s44, 1
    s_cbranch_scc0 NON_1
NOND_2:
    v_mov_b32 v246, s42
    v_mov_b32 v247, s43
    v_mov_b32 v248, 0
    s_mov_b64 exec, 1
    buffer_store_dwordx2 v[246:247], v248, s[28:31], s26 offen sc1
    s_mov_b64 exec, -1
    s_cmp_lg_u32 s36, 3
    s_cbranch_scc1 L_NOHELLO
    s_getreg_b32 s48, hwreg(HW_REG_XCC_ID, 0, 4)
    s_lshl_b32 s48, s48, 28
    s_xor_b32 s48, s48, s43
    s_lshl_b32 s45, s38, 7
    s_add_u32 s45, s45, s95
    v_mov_b32 v246, s42
    v_mov_b32 v247, s48
    v_mov_b32 v248, 0
    s_mov_b64 exec, 1
    buffer_store_dwordx2 v[246:247], v248, s[28:31], s45 offen sc1
    s_mov_b64 exec, -1
    v_mov_b32 v3, 142848
    v_mov_b32 v247, s43
    ds_write_b64 v3, v[246:247]
L_NOHELLO:
    s_waitcnt lgkmcnt(0)
    v_mfma_f32_32x32x16_bf16 v[8:23], v[64:67], v[100:103], v[8:23]
    v_mfma_f32_32x32x16_bf16 v[24:39], v[100:103], v[68:71], v[24:39]
    s_barrier
    ds_read_b128 v[104:107], v204 offset:0
    ds_read_b64_tr_b16 v[40:41], v209 offset:0
    ds_read_b64_tr_b16 v[42:43], v209 offset:512
    ds_read_b64_tr_b16 v[44:45], v209 offset:1024
    ds_read_b64_tr_b16 v[46:47], v209 offset:1536
    ds_read_b128 v[108:111], v205 offset:0
    ds_read_b64_tr_b16 v[48:49], v209 offset:6144
    ds_read_b64_tr_b16 v[50:51], v209 offset:6656
    ds_read_b64_tr_b16 v[52:53], v209 offset:7168
    ds_read_b64_tr_b16 v[54:55], v209 offset:7680
    s_waitcnt lgkmcnt(5)
    v_mfma_f32_32x32x16_bf16 v[8:23], v[40:43], v[104:107], v[8:23]
    ds_read_b128 v[112:115], v206 offset:0
    ds_read_b64_tr_b16 v[56:57], v209 offset:12288
    ds_read_b64_tr_b16 v[58:59], v209 offset:12800
    v_mfma_f32_32x32x16_bf16 v[24:39], v[104:107], v[44:47], v[24:39]
    ds_read_b64_tr_b16 v[60:61], v209 offset:13312
    ds_read_b64_tr_b16 v[62:63], v209 offset:13824
    ds_read_b128 v[116:119], v207 offset:0
    s_waitcnt lgkmcnt(6)
    v_mfma_f32_32x32x16_bf16 v[8:23], v[48:51], v[108:111], v[8:23]
    ds_read_b64_tr_b16 v[64:65], v209 offset:18432
    ds_read_b64_tr_b16 v[66:67], v209 offset:18944
    v_mfma_f32_32x32x16_bf16 v[24:39], v[108:111], v[52:55], v[24:39]
    ds_read_b64_tr_b16 v[68:69], v209 offset:19456
    ds_read_b64_tr_b16 v[70:71], v209 offset:19968
    s_waitcnt lgkmcnt(5)
    v_mfma_f32_32x32x16_bf16 v[8:23], v[56:59], v[112:115], v[8:23]
    v_mfma_f32_32x32x16_bf16 v[24:39], v[112:115], v[60:63], v[24:39]
    s_waitcnt lgkmcnt(0)
    v_mfma_f32_32x32x16_bf16 v[8:23], v[64:67], v[116:119], v[8:23]
    v_mfma_f32_32x32x16_bf16 v[24:39], v[116:119], v[68:71], v[24:39]
    s_barrier
    ds_read_b128 v[120:123], v204 offset:24576
    ds_read_b64_tr_b16 v[40:41], v209 offset:24576
    ds_read_b64_tr_b16 v[42:43], v209 offset:25088
    ds_read_b64_tr_b16 v[44:45], v209 offset:25600
    ds_read_b64_tr_b16 v[46:47], v209 offset:26112
    ds_read_b128 v[124:127], v205 offset:24576
    ds_read_b64_tr_b16 v[48:49], v209 offset:30720
    ds_read_b64_tr_b16 v[50:51], v209 offset:31232
    ds_read_b64_tr_b16 v[52:53], v209 offset:31744
    ds_read_b64_tr_b16 v[54:55], v209 offset:32256
    s_waitcnt lgkmcnt(5)
    v_mfma_f32_32x32x16_bf16 v[8:23], v[40:43], v[120:123], v[8:23]
    ds_read_b128 v[128:131], v206 offset:24576
    ds_read_b64_tr_b16 v[56:57], v209 offset:36864
    ds_read_b64_tr_b16 v[58:59], v209 offset:37376
    v_mfma_f32_32x32x16_bf16 v[24:39], v[120:123], v[44:47], v[24:39]
    ds_read_b64_tr_b16 v[60:61], v209 offset:37888
    ds_read_b64_tr_b16 v[62:63], v209 offset:38400
    ds_read_b128 v[132:135], v207 offset:24576
    s_waitcnt lgkmcnt(6)
    v_mfma_f32_32x32x16_bf16 v[8:23], v[48:51], v[124:127], v[8:23]
    ds_read_b64_tr_b16 v[64:65], v209 offset:43008
    ds_read_b64_tr_b16 v[66:67], v209 offset:43520
    v_mfma_f32_32x32x16_bf16 v[24:39], v[124:127], v[52:55], v[24:39]
    ds_read_b64_tr_b16 v[68:69], v209 offset:44032
    ds_read_b64_tr_b16 v[70:71], v209 offset:44544
    s_waitcnt lgkmcnt(5)
    v_mfma_f32_32x32x16_bf16 v[8:23], v[56:59], v[128:131], v[8:23]
    v_mfma_f32_32x32x16_bf16 v[24:39], v[128:131], v[60:63], v[24:39]
    s_waitcnt lgkmcnt(0)
    v_mfma_f32_32x32x16_bf16 v[8:23], v[64:67], v[132:135], v[8:23]
    v_mfma_f32_32x32x16_bf16 v[24:39], v[132:135], v[68:71], v[24:39]
    s_barrier
    ds_read_b128 v[136:139], v200 offset:0
    ds_read_b64_tr_b16 v[40:41], v208 offset:0
    ds_read_b64_tr_b16 v[42:43], v208 offset:512
    ds_read_b64_tr_b16 v[44:45], v208 offset:1024
    ds_read_b64_tr_b16 v[46:47], v208 offset:1536
    ds_read_b128 v[140:143], v201 offset:0
    ds_read_b64_tr_b16 v[48:49], v208 offset:6144
    ds_read_b64_tr_b16 v[50:51], v208 offset:6656
    ds_read_b64_tr_b16 v[52:53], v208 offset:7168
    ds_read_b64_tr_b16 v[54:55], v208 offset:7680
    s_waitcnt lgkmcnt(5)
    v_mfma_f32_32x32x16_bf16 v[8:23], v[40:43], v[136:139], v[8:23]
    ds_read_b128 v[144:147], v202 offset:0
    ds_read_b64_tr_b16 v[56:57], v208 offset:12288
    ds_read_b64_tr_b16 v[58:59], v208 offset:12800
    v_mfma_f32_32x32x16_bf16 v[24:39], v[136:139], v[44:47], v[24:39]
    ds_read_b64_tr_b16 v[60:61], v208 offset:13312
    ds_read_b64_tr_b16 v[62:63], v208 offset:13824
    ds_read_b128 v[148:151], v203 offset:0
    s_waitcnt lgkmcnt(6)
    v_mfma_f32_32x32x16_bf16 v[8:23], v[48:51], v[140:143], v[8:23]
    ds_read_b64_tr_b16 v[64:65], v208 offset:18432
    ds_read_b64_tr_b16 v[66:67], v208 offset:18944
    v_mfma_f32_32x32x16_bf16 v[24:39], v[140:143], v[52:55], v[24:39]
    ds_read_b64_tr_b16 v[68:69], v208 offset:19456
    ds_read_b64_tr_b16 v[70:71], v208 offset:19968
    s_waitcnt lgkmcnt(5)
    v_mfma_f32_32x32x16_bf16 v[8:23], v[56:59], v[144:147], v[8:23]
    v_mfma_f32_32x32x16_bf16 v[24:39], v[144:147], v[60:63], v[24:39]
    s_waitcnt lgkmcnt(0)
    v_mfma_f32_32x32x16_bf16 v[8:23], v[64:67], v[148:151], v[8:23]
    v_mfma_f32_32x32x16_bf16 v[24:39], v[148:151], v[68:71], v[24:39]
    s_cmp_lg_u32 s36, 3
    s_cbranch_scc1 L_NOH2
    v_and_b32 v248, 7, v1
    v_lshlrev_b32 v248, 7, v248
    buffer_load_dwordx2 v[246:247], v248, s[28:31], s95 offen sc1
L_NOH2:
    s_barrier
    ds_read_b128 v[152:155], v200 offset:24576
    ds_read_b64_tr_b16 v[40:41], v208 offset:24576
    ds_read_b64_tr_b16 v[42:43], v208 offset:25088
    ds_read_b64_tr_b16 v[44:45], v208 offset:25600
    ds_read_b64_tr_b16 v[46:47], v208 offset:26112
    ds_read_b128 v[156:159], v201 offset:24576
    ds_read_b64_tr_b16 v[48:49], v208 offset:30720
    ds_read_b64_tr_b16 v[50:51], v208 offset:31232
    ds_read_b64_tr_b16 v[52:53], v208 offset:31744
    ds_read_b64_tr_b16 v[54:55], v208 offset:32256
    s_waitcnt lgkmcnt(5)
    v_mfma_f32_32x32x16_bf16 v[8:23], v[40:43], v[152:155], v[8:23]
    ds_read_b128 v[160:163], v202 offset:24576
    ds_read_b64_tr_b16 v[56:57], v208 offset:36864
    ds_read_b64_tr_b16 v[58:59], v208 offset:37376
    v_mfma_f32_32x32x16_bf16 v[24:39], v[152:155], v[44:47], v[24:39]
    ds_read_b64_tr_b16 v[60:61], v208 offset:37888
    ds_read_b64_tr_b16 v[62:63], v208 offset:38400
    ds_read_b128 v[164:167], v203 offset:24576
    s_waitcnt lgkmcnt(6)
    v_mfma_f32_32x32x16_bf16 v[8:23], v[48:51], v[156:159], v[8:23]
    ds_read_b64_tr_b16 v[64:65], v208 offset:43008
    ds_read_b64_tr_b16 v[66:67], v208 offset:43520
    v_mfma_f32_32x32x16_bf16 v[24:39], v[156:159], v[52:55], v[24:39]
    ds_read_b64_tr_b16 v[68:69], v208 offset:44032
    ds_read_b64_tr_b16 v[70:71], v208 offset:44544
    s_waitcnt lgkmcnt(5)
    v_mfma_f32_32x32x16_bf16 v[8:23], v[56:59], v[160:163], v[8:23]
    v_mfma_f32_32x32x16_bf16 v[24:39], v[160:163], v[60:63], v[24:39]
    s_waitcnt lgkmcnt(0)
    v_mfma_f32_32x32x16_bf16 v[8:23], v[64:67], v[164:167], v[8:23]
    v_mfma_f32_32x32x16_bf16 v[24:39], v[164:167], v[68:71], v[24:39]
    s_barrier
    ds_read_b128 v[168:171], v204 offset:0
    ds_read_b64_tr_b16 v[40:41], v209 offset:0
    ds_read_b64_tr_b16 v[42:43], v209 offset:512
    ds_read_b64_tr_b16 v[44:45], v209 offset:1024
    ds_read_b64_tr_b16 v[46:47], v209 offset:1536
    ds_read_b128 v[172:175], v205 offset:0
    ds_read_b64_tr_b16 v[48:49], v209 offset:6144
    ds_read_b64_tr_b16 v[50:51], v209 offset:6656
    ds_read_b64_tr_b16 v[52:53], v209 offset:7168
    ds_read_b64_tr_b16 v[54:55], v209 offset:7680
    s_waitcnt lgkmcnt(5)
    v_mfma_f32_32x32x16_bf16 v[8:23], v[40:43], v[168:171], v[8:23]
    ds_read_b128 v[176:179], v206 offset:0
    ds_read_b64_tr_b16 v[56:57], v209 offset:12288
    ds_read_b64_tr_b16 v[58:59], v209 offset:12800
    v_mfma_f32_32x32x16_bf16 v[24:39], v[168:171], v[44:47], v[24:39]
    ds_read_b64_tr_b16 v[60:61], v209 offset:13312
    ds_read_b64_tr_b16 v[62:63], v209 offset:13824
    ds_read_b128 v[180:183], v207 offset:0
    s_waitcnt lgkmcnt(6)
    v_mfma_f32_32x32x16_bf16 v[8:23], v[48:51], v[172:175], v[8:23]
    ds_read_b64_tr_b16 v[64:65], v209 offset:18432
    ds_read_b64_tr_b16 v[66:67], v209 offset:18944
    v_mfma_f32_32x32x16_bf16 v[24:39], v[172:175], v[52:55], v[24:39]
    ds_read_b64_tr_b16 v[68:69], v209 offset:19456
    ds_read_b64_tr_b16 v[70:71], v209 offset:19968
    s_waitcnt lgkmcnt(5)
    v_mfma_f32_32x32x16_bf16 v[8:23], v[56:59], v[176:179], v[8:23]
    v_mfma_f32_32x32x16_bf16 v[24:39], v[176:179], v[60:63], v[24:39]
    s_waitcnt lgkmcnt(0)
    v_mfma_f32_32x32x16_bf16 v[8:23], v[64:67], v[180:183], v[8:23]
    v_mfma_f32_32x32x16_bf16 v[24:39], v[180:183], v[68:71], v[24:39]
    s_barrier
    ds_read_b128 v[184:187], v204 offset:24576
    ds_read_b64_tr_b16 v[40:41], v209 offset:24576
    ds_read_b64_tr_b16 v[42:43], v209 offset:25088
    ds_read_b64_tr_b16 v[44:45], v209 offset:25600
    ds_read_b64_tr_b16 v[46:47], v209 offset:26112
    ds_read_b128 v[188:191], v205 offset:24576
    ds_read_b64_tr_b16 v[48:49], v209 offset:30720
    ds_read_b64_tr_b16 v[50:51], v209 offset:31232
    ds_read_b64_tr_b16 v[52:53], v209 offset:31744
    ds_read_b64_tr_b16 v[54:55], v209 offset:32256
    s_waitcnt lgkmcnt(5)
    v_mfma_f32_32x32x16_bf16 v[8:23], v[40:43], v[184:187], v[8:23]
    ds_read_b128 v[192:195], v206 offset:24576
    ds_read_b64_tr_b16 v[56:57], v209 offset:36864
    ds_read_b64_tr_b16 v[58:59], v209 offset:37376
    v_mfma_f32_32x32x16_bf16 v[24:39], v[184:187], v[44:47], v[24:39]
    ds_read_b64_tr_b16 v[60:61], v209 offset:37888
    ds_read_b64_tr_b16 v[62:63], v209 offset:38400
    ds_read_b128 v[196:199], v207 offset:24576
    s_waitcnt lgkmcnt(6)
    v_mfma_f32_32x32x16_bf16 v[8:23], v[48:51], v[188:191], v[8:23]
    ds_read_b64_tr_b16 v[64:65], v209 offset:43008
    ds_read_b64_tr_b16 v[66:67], v209 offset:43520
    v_mfma_f32_32x32x16_bf16 v[24:39], v[188:191], v[52:55], v[24:39]
    ds_read_b64_tr_b16 v[68:69], v209 offset:44032
    ds_read_b64_tr_b16 v[70:71], v209 offset:44544
    s_waitcnt lgkmcnt(5)
    v_mfma_f32_32x32x16_bf16 v[8:23], v[56:59], v[192:195], v[8:23]
    s_waitcnt lgkmcnt(2)
    v_mfma_f32_32x32x16_bf16 v[8:23], v[64:67], v[196:199], v[8:23]
    v_mfma_f32_32x32x16_bf16 v[24:39], v[192:195], v[60:63], v[24:39]
    s_waitcnt lgkmcnt(0)
    v_mfma_f32_32x32x16_bf16 v[24:39], v[196:199], v[68:71], v[24:39]
    s_nop 8
    v_cvt_pk_bf16_f32 v56, v8, v9
    v_cvt_pk_bf16_f32 v57, v10, v11
    v_cvt_pk_bf16_f32 v58, v12, v13
    v_cvt_pk_bf16_f32 v59, v14, v15
    v_cvt_pk_bf16_f32 v60, v16, v17
    v_cvt_pk_bf16_f32 v61, v18, v19
    v_cvt_pk_bf16_f32 v62, v20, v21
    v_cvt_pk_bf16_f32 v63, v22, v23
    buffer_store_dwordx4 v[56:59], v211, s[28:31], s6 offen sc1
    buffer_store_dwordx4 v[60:63], v211, s[28:31], s6 offen offset:2048 sc1
    v_cvt_pk_bf16_f32 v64, v24, v25
    v_cvt_pk_bf16_f32 v65, v26, v27
    v_cvt_pk_bf16_f32 v66, v28, v29
    v_cvt_pk_bf16_f32 v67, v30, v31
    v_cvt_pk_bf16_f32 v68, v32, v33
    v_cvt_pk_bf16_f32 v69, v34, v35
    v_cvt_pk_bf16_f32 v70, v36, v37
    v_cvt_pk_bf16_f32 v71, v38, v39
    buffer_store_dwordx4 v[64:67], v245, s[28:31], s6 offen sc1
    buffer_store_dwordx4 v[68:71], v245, s[28:31], s6 offen offset:512 sc1
    ds_read_b128 v[8:11], v251
    ds_read_b128 v[12:15], v251 offset:1024
    s_set_gpr_idx_on s52, gpr_idx(SRC0)
    s_nop 1
    v_mov_b32 v200, v72
    v_mov_b32 v201, v73
    v_mov_b32 v202, v74
    v_mov_b32 v203, v75
    v_mov_b32 v204, v76
    v_mov_b32 v205, v77
    v_mov_b32 v206, v78
    v_mov_b32 v207, v79
    s_set_gpr_idx_off
    s_barrier
    s_add_u32 s45, s90, 1
    s_and_b32 s45, s45, 7
    s_mul_i32 s48, s45, 196608
    s_add_u32 s48, s48, s7
    s_add_u32 m0, s24, 8192
    s_add_u32 s50, s48, 24576
    buffer_load_dwordx4 v244, s[8:11], s48 offen lds
    s_add_u32 m0, s24, 9216
    s_nop 0
    buffer_load_dwordx4 v244, s[8:11], s50 offen lds
    s_add_u32 s45, s90, 2
    s_and_b32 s45, s45, 7
    s_mul_i32 s48, s45, 196608
    s_add_u32 s48, s48, s7
    s_add_u32 m0, s24, 16384
    s_add_u32 s50, s48, 24576
    buffer_load_dwordx4 v244, s[8:11], s48 offen lds
    s_add_u32 m0, s24, 17408
    s_nop 0
    buffer_load_dwordx4 v244, s[8:11], s50 offen lds
    s_add_u32 s45, s90, 3
    s_and_b32 s45, s45, 7
    s_mul_i32 s48, s45, 196608
    s_add_u32 s48, s48, s7
    s_add_u32 m0, s24, 24576
    s_add_u32 s50, s48, 24576
    buffer_load_dwordx4 v244, s[8:11], s48 offen lds
    s_add_u32 m0, s24, 25600
    s_nop 0
    buffer_load_dwordx4 v244, s[8:11], s50 offen lds
    ds_read_b32 v208, v250
    ds_read_b32 v209, v250 offset:256
    ds_write_b128 v4, v[56:59]
    ds_write_b128 v4, v[60:63] offset:2048
    ds_write_b128 v5, v[64:67]
    ds_write_b128 v5, v[68:71] offset:512
    v_permlane32_swap_b32 v200, v204
    v_permlane32_swap_b32 v201, v205
    v_permlane32_swap_b32 v202, v206
    v_permlane32_swap_b32 v203, v207
    s_cmp_lg_u32 s36, 3
    s_cbranch_scc1 L_NOH3
    s_waitcnt vmcnt(10)
    s_mov_b32 s44, 200000
    s_branch POLLC_5
POLL_3:
    buffer_load_dwordx2 v[246:247], v248, s[28:31], s95 offen sc1
    s_waitcnt vmcnt(0)
POLLC_5:
    v_xor_b32 v247, s43, v247
    v_cmp_ne_u32 vcc, s42, v246
    v_and_b32 v246, 0x0fffffff, v247
    v_cmp_ne_u32 s[50:51], 0, v246
    s_nop 0
    s_or_b64 vcc, vcc, s[50:51]
    s_sub_u32 s44, s44, 1
    s_cbranch_scc1 POLLD_4
    s_cbranch_vccnz POLL_3
POLLD_4:
    s_getreg_b32 s48, hwreg(HW_REG_XCC_ID, 0, 4)
    s_lshl_b32 s48, s48, 28
    v_cmp_ne_u32 vcc, s48, v247
    s_nop 0
    s_cmp_eq_u64 vcc, 0
    s_cselect_b32 s41, 1, 0
    v_mov_b32 v246, s41
    v_mov_b32 v3, 68624
    ds_write_b32 v3, v246
    s_waitcnt lgkmcnt(0)
L_NOH3:
    s_waitcnt vmcnt(6)
    v_mov_b32 v246, s42
    v_mov_b32 v247, s43
    v_mov_b32 v248, 0
    s_mov_b64 exec, 1
    buffer_store_dwordx2 v[246:247], v248, s[28:31], s27 offen sc1
    s_mov_b64 exec, -1
    s_add_u32 s45, s90, 4
    s_and_b32 s45, s45, 7
    s_mul_i32 s48, s45, 196608
    s_add_u32 s48, s48, s7
    s_add_u32 m0, s24, 32768
    s_add_u32 s50, s48, 24576
    buffer_load_dwordx4 v244, s[8:11], s48 offen lds
    s_add_u32 m0, s24, 33792
    s_nop 0
    buffer_load_dwordx4 v244, s[8:11], s50 offen lds
    s_add_u32 s45, s90, 5
    s_and_b32 s45, s45, 7
    s_mul_i32 s48, s45, 196608
    s_add_u32 s48, s48, s7
    s_add_u32 m0, s24, 40960
    s_add_u32 s50, s48, 24576
    buffer_load_dwordx4 v244, s[8:11], s48 offen lds
    s_add_u32 m0, s24, 41984
    s_nop 0
    buffer_load_dwordx4 v244, s[8:11], s50 offen lds
    s_add_u32 s45, s90, 6
    s_and_b32 s45, s45, 7
    s_mul_i32 s48, s45, 196608
    s_add_u32 s48, s48, s7
    s_add_u32 m0, s24, 49152
    s_add_u32 s50, s48, 24576
    buffer_load_dwordx4 v244, s[8:11], s48 offen lds
    s_add_u32 m0, s24, 50176
    s_nop 0
    buffer_load_dwordx4 v244, s[8:11], s50 offen lds
    s_add_u32 s45, s90, 7
    s_and_b32 s45, s45, 7
    s_mul_i32 s48, s45, 196608
    s_add_u32 s48, s48, s7
    s_add_u32 m0, s24, 57344
    s_add_u32 s50, s48, 24576
    buffer_load_dwordx4 v244, s[8:11], s48 offen lds
    s_add_u32 m0, s24, 58368
    s_nop 0
    buffer_load_dwordx4 v244, s[8:11], s50 offen lds
    s_waitcnt vmcnt(9) lgkmcnt(0)
    s_barrier
    ds_read_b64_tr_b16 v[32:33], v210 offset:0
    ds_read_b64_tr_b16 v[34:35], v210 offset:512
    ds_read_b64_tr_b16 v[36:37], v210 offset:2048
    ds_read_b64_tr_b16 v[38:39], v210 offset:2560
    ds_read_b64_tr_b16 v[40:41], v210 offset:4096
    ds_read_b64_tr_b16 v[42:43], v210 offset:4608
    ds_read_b64_tr_b16 v[44:45], v210 offset:6144
    ds_read_b64_tr_b16 v[46:47], v210 offset:6656
    ds_read_b64_tr_b16 v[48:49], v210 offset:8192
    ds_read_b64_tr_b16 v[50:51], v210 offset:8704
    ds_read_b64_tr_b16 v[52:53], v210 offset:10240
    ds_read_b64_tr_b16 v[54:55], v210 offset:10752
    s_waitcnt lgkmcnt(10)
    v_mfma_f32_32x32x16_bf16 v[16:31], v[32:35], v[72:75], 0
    ds_read_b64_tr_b16 v[60:61], v210 offset:12288
    ds_read_b64_tr_b16 v[62:63], v210 offset:12800
    s_waitcnt lgkmcnt(10)
    v_mfma_f32_32x32x16_bf16 v[16:31], v[36:39], v[76:79], v[16:31]
    ds_read_b64_tr_b16 v[64:65], v210 offset:14336
    ds_read_b64_tr_b16 v[66:67], v210 offset:14848
    s_waitcnt lgkmcnt(10)
    v_mfma_f32_32x32x16_bf16 v[16:31], v[40:43], v[80:83], v[16:31]
    ds_read_b64_tr_b16 v[32:33], v210 offset:16384
    ds_read_b64_tr_b16 v[34:35], v210 offset:16896
    s_waitcnt lgkmcnt(10)
    v_mfma_f32_32x32x16_bf16 v[16:31], v[44:47], v[84:87], v[16:31]
    ds_read_b64_tr_b16 v[36:37], v210 offset:18432
    ds_read_b64_tr_b16 v[38:39], v210 offset:18944
    s_waitcnt lgkmcnt(10)
    v_mfma_f32_32x32x16_bf16 v[16:31], v[48:51], v[88:91], v[16:31]
    ds_read_b64_tr_b16 v[40:41], v210 offset:20480
    ds_read_b64_tr_b16 v[42:43], v210 offset:20992
    s_waitcnt lgkmcnt(10)
    v_mfma_f32_32x32x16_bf16 v[16:31], v[52:55], v[92:95], v[16:31]
    ds_read_b64_tr_b16 v[44:45], v210 offset:22528
    ds_read_b64_tr_b16 v[46:47], v210 offset:23040
    s_waitcnt lgkmcnt(10)
    v_mfma_f32_32x32x16_bf16 v[16:31], v[60:63], v[96:99], v[16:31]
    ds_read_b64_tr_b16 v[48:49], v210 offset:24576
    ds_read_b64_tr_b16 v[50:51], v210 offset:25088
    s_waitcnt lgkmcnt(10)
    v_mfma_f32_32x32x16_bf16 v[16:31], v[64:67], v[100:103], v[16:31]
    ds_read_b64_tr_b16 v[52:53], v210 offset:26624
    ds_read_b64_tr_b16 v[54:55], v210 offset:27136
    s_waitcnt lgkmcnt(10)
    v_mfma_f32_32x32x16_bf16 v[16:31], v[32:35], v[104:107], v[16:31]
    ds_read_b64_tr_b16 v[60:61], v210 offset:28672
    ds_read_b64_tr_b16 v[62:63], v210 offset:29184
    s_waitcnt lgkmcnt(10)
    v_mfma_f32_32x32x16_bf16 v[16:31], v[36:39], v[108:111], v[16:31]
    ds_read_b64_tr_b16 v[64:65], v210 offset:30720
    ds_read_b64_tr_b16 v[66:67], v210 offset:31232
    s_waitcnt lgkmcnt(10)
    v_mfma_f32_32x32x16_bf16 v[16:31], v[40:43], v[112:115], v[16:31]
    s_waitcnt lgkmcnt(8)
    v_mfma_f32_32x32x16_bf16 v[16:31], v[44:47], v[116:119], v[16:31]
    s_waitcnt lgkmcnt(6)
    v_mfma_f32_32x32x16_bf16 v[16:31], v[48:51], v[120:123], v[16:31]
    s_waitcnt lgkmcnt(4)
    v_mfma_f32_32x32x16_bf16 v[16:31], v[52:55], v[124:127], v[16:31]
    s_waitcnt lgkmcnt(2)
    v_mfma_f32_32x32x16_bf16 v[16:31], v[60:63], v[128:131], v[16:31]
    s_waitcnt lgkmcnt(0)
    v_mfma_f32_32x32x16_bf16 v[16:31], v[64:67], v[132:135], v[16:31]
    v_mov_b64 v[76:77], v[228:229]
    v_mov_b64 v[78:79], v[228:229]
    v_mov_b64 v[80:81], v[228:229]
    v_mov_b64 v[82:83], v[228:229]
    v_mov_b64 v[88:89], v[228:229]
    v_mov_b64 v[90:91], v[228:229]
    v_mov_b64 v[92:93], v[228:229]
    v_mov_b64 v[94:95], v[228:229]
    v_mov_b64 v[100:101], v[228:229]
    v_mov_b64 v[102:103], v[228:229]
    v_mov_b64 v[104:105], v[228:229]
    v_mov_b64 v[106:107], v[228:229]
    v_mov_b64 v[112:113], v[228:229]
    v_mov_b64 v[114:115], v[228:229]
    v_mov_b64 v[116:117], v[228:229]
    v_mov_b64 v[118:119], v[228:229]
    ds_read_b128 v[248:251], v12 offset:8192
    s_mov_b64 exec, s[60:61]
    ds_read_b128 v[236:239], v13 offset:8192
    ds_read_b128 v[240:243], v13 offset:8704
    s_mov_b64 exec, -1
    ds_read_b128 v[244:247], v12 offset:0
    s_mov_b64 exec, s[60:61]
    ds_read_b128 v[228:231], v13 offset:0
    ds_read_b128 v[232:235], v13 offset:512
    s_mov_b64 exec, -1
    s_waitcnt vmcnt(0)
    s_barrier
    ds_read_b64_tr_b16 v[32:33], v210 offset:32768
    ds_read_b64_tr_b16 v[34:35], v210 offset:33280
    ds_read_b64_tr_b16 v[36:37], v210 offset:34816
    ds_read_b64_tr_b16 v[38:39], v210 offset:35328
    ds_read_b64_tr_b16 v[40:41], v210 offset:36864
    ds_read_b64_tr_b16 v[42:43], v210 offset:37376
    ds_read_b64_tr_b16 v[44:45], v210 offset:38912
    ds_read_b64_tr_b16 v[46:47], v210 offset:39424
    ds_read_b64_tr_b16 v[48:49], v210 offset:40960
    ds_read_b64_tr_b16 v[50:51], v210 offset:41472
    ds_read_b64_tr_b16 v[52:53], v210 offset:43008
    ds_read_b64_tr_b16 v[54:55], v210 offset:43520
    s_waitcnt lgkmcnt(10)
    v_mfma_f32_32x32x16_bf16 v[16:31], v[32:35], v[136:139], v[16:31]
    ds_read_b64_tr_b16 v[60:61], v210 offset:45056
    ds_read_b64_tr_b16 v[62:63], v210 offset:45568
    s_waitcnt lgkmcnt(10)
    v_mfma_f32_32x32x16_bf16 v[16:31], v[36:39], v[140:143], v[16:31]
    ds_read_b64_tr_b16 v[64:65], v210 offset:47104
    ds_read_b64_tr_b16 v[66:67], v210 offset:47616
    s_waitcnt lgkmcnt(10)
    v_mfma_f32_32x32x16_bf16 v[16:31], v[40:43], v[144:147], v[16:31]
    ds_read_b64_tr_b16 v[32:33], v210 offset:49152
    ds_read_b64_tr_b16 v[34:35], v210 offset:49664
    s_waitcnt lgkmcnt(10)
    v_mfma_f32_32x32x16_bf16 v[16:31], v[44:47], v[148:151], v[16:31]
    ds_read_b64_tr_b16 v[36:37], v210 offset:51200
    ds_read_b64_tr_b16 v[38:39], v210 offset:51712
    s_waitcnt lgkmcnt(10)
    v_mfma_f32_32x32x16_bf16 v[16:31], v[48:51], v[152:155], v[16:31]
    ds_read_b64_tr_b16 v[40:41], v210 offset:53248
    ds_read_b64_tr_b16 v[42:43], v210 offset:53760
    s_waitcnt lgkmcnt(10)
    v_mfma_f32_32x32x16_bf16 v[16:31], v[52:55], v[156:159], v[16:31]
    ds_read_b64_tr_b16 v[44:45], v210 offset:55296
    ds_read_b64_tr_b16 v[46:47], v210 offset:55808
    s_waitcnt lgkmcnt(10)
    v_mfma_f32_32x32x16_bf16 v[16:31], v[60:63], v[160:163], v[16:31]
    ds_read_b64_tr_b16 v[48:49], v210 offset:57344
    ds_read_b64_tr_b16 v[50:51], v210 offset:57856
    s_waitcnt lgkmcnt(10)
    v_mfma_f32_32x32x16_bf16 v[16:31], v[64:67], v[164:167], v[16:31]
    ds_read_b64_tr_b16 v[52:53], v210 offset:59392
    ds_read_b64_tr_b16 v[54:55], v210 offset:59904
    s_waitcnt lgkmcnt(10)
    v_mfma_f32_32x32x16_bf16 v[16:31], v[32:35], v[168:171], v[16:31]
    ds_read_b64_tr_b16 v[60:61], v210 offset:61440
    ds_read_b64_tr_b16 v[62:63], v210 offset:61952
    s_waitcnt lgkmcnt(10)
    v_mfma_f32_32x32x16_bf16 v[16:31], v[36:39], v[172:175], v[16:31]
    ds_read_b64_tr_b16 v[64:65], v210 offset:63488
    ds_read_b64_tr_b16 v[66:67], v210 offset:64000
    s_waitcnt lgkmcnt(10)
    v_mfma_f32_32x32x16_bf16 v[16:31], v[40:43], v[176:179], v[16:31]
    s_waitcnt lgkmcnt(8)
    v_mfma_f32_32x32x16_bf16 v[16:31], v[44:47], v[180:183], v[16:31]
    s_waitcnt lgkmcnt(6)
    v_mfma_f32_32x32x16_bf16 v[16:31], v[48:51], v[184:187], v[16:31]
    s_waitcnt lgkmcnt(4)
    v_mfma_f32_32x32x16_bf16 v[16:31], v[52:55], v[188:191], v[16:31]
    s_waitcnt lgkmcnt(2)
    v_mfma_f32_32x32x16_bf16 v[16:31], v[60:63], v[192:195], v[16:31]
    s_waitcnt lgkmcnt(0)
    v_mfma_f32_32x32x16_bf16 v[16:31], v[64:67], v[196:199], v[16:31]
    s_mov_b32 s48, 0x3eb8aa3b
    s_mov_b32 s49, s48
    s_nop 9
    v_pk_mul_f32 v[16:17], v[16:17], s[48:49]
    v_pk_mul_f32 v[18:19], v[18:19], s[48:49]
    v_pk_mul_f32 v[20:21], v[20:21], s[48:49]
    v_pk_mul_f32 v[22:23], v[22:23], s[48:49]
    v_pk_mul_f32 v[24:25], v[24:25], s[48:49]
    v_pk_mul_f32 v[26:27], v[26:27], s[48:49]
    v_pk_mul_f32 v[28:29], v[28:29], s[48:49]
    v_pk_mul_f32 v[30:31], v[30:31], s[48:49]
    v_cvt_pk_bf16_f32 v32, v16, v17
    v_cvt_pk_bf16_f32 v33, v18, v19
    v_cvt_pk_bf16_f32 v34, v20, v21
    v_cvt_pk_bf16_f32 v35, v22, v23
    ds_write_b128 v6, v[32:35]
    v_cvt_pk_bf16_f32 v36, v24, v25
    v_cvt_pk_bf16_f32 v37, v26, v27
    v_cvt_pk_bf16_f32 v38, v28, v29
    v_cvt_pk_bf16_f32 v39, v30, v31
    ds_write_b128 v6, v[36:39] offset:1024
    s_waitcnt lgkmcnt(0)
    s_barrier
    ds_read_b128 v[124:127], v14 offset:4096
    ds_read_b128 v[120:123], v14
    s_waitcnt lgkmcnt(0)
    v_mfma_f32_32x32x16_bf16 v[16:31], v[248:251], v[124:127], v[212:227]
    s_sub_u32 s45, s94, 8192
    s_max_u32 s45, s45, s3
    buffer_load_dwordx4 v[72:75], v211, s[28:31], s45 offen sc1
    s_sub_u32 s45, s94, 8192
    s_max_u32 s45, s45, s3
    s_mov_b64 exec, s[60:61]
    buffer_load_dwordx4 v[76:79], v253, s[28:31], s45 offen sc1
    buffer_load_dwordx4 v[80:83], v253, s[28:31], s45 offen offset:512 sc1
    s_mov_b64 exec, -1
    s_nop 2
    v_exp_f32 v16, v16
    v_exp_f32 v17, v17
    v_exp_f32 v18, v18
    v_exp_f32 v19, v19
    v_exp_f32 v20, v20
    v_exp_f32 v21, v21
    v_mfma_f32_32x32x16_bf16 v[32:47], v[244:247], v[124:127], 0
    v_exp_f32 v22, v22
    v_exp_f32 v23, v23
    v_cvt_pk_bf16_f32 v48, v16, v17
    v_cvt_pk_bf16_f32 v49, v18, v19
    v_cvt_pk_bf16_f32 v50, v20, v21
    v_cvt_pk_bf16_f32 v51, v22, v23
    v_exp_f32 v24, v24
    v_exp_f32 v25, v25
    v_mfma_f32_32x32x16_bf16 v[128:143], v[236:239], v[48:51], 0
    s_sub_u32 s45, s94, 16384
    s_max_u32 s45, s45, s3
    buffer_load_dwordx4 v[84:87], v211, s[28:31], s45 offen sc1
    s_sub_u32 s45, s94, 16384
    s_max_u32 s45, s45, s3
    s_mov_b64 exec, s[60:61]
    buffer_load_dwordx4 v[88:91], v253, s[28:31], s45 offen sc1
    buffer_load_dwordx4 v[92:95], v253, s[28:31], s45 offen offset:512 sc1
    s_mov_b64 exec, -1
    v_exp_f32 v26, v26
    v_exp_f32 v27, v27
    v_exp_f32 v28, v28
    v_exp_f32 v29, v29
    v_exp_f32 v30, v30
    v_exp_f32 v31, v31
    v_cvt_pk_bf16_f32 v52, v24, v25
    v_cvt_pk_bf16_f32 v53, v26, v27
    v_cvt_pk_bf16_f32 v54, v28, v29
    v_cvt_pk_bf16_f32 v55, v30, v31
    s_sub_u32 s45, s94, 24576
    s_max_u32 s45, s45, s3
    buffer_load_dwordx4 v[96:99], v211, s[28:31], s45 offen sc1
    s_sub_u32 s45, s94, 24576
    s_max_u32 s45, s45, s3
    s_mov_b64 exec, s[60:61]
    buffer_load_dwordx4 v[100:103], v253, s[28:31], s45 offen sc1
    buffer_load_dwordx4 v[104:107], v253, s[28:31], s45 offen offset:512 sc1
    s_mov_b64 exec, -1
    v_exp_f32 v32, v32
    v_exp_f32 v33, v33
    v_mfma_f32_32x32x16_bf16 v[128:143], v[240:243], v[52:55], v[128:143]
    v_exp_f32 v34, v34
    v_exp_f32 v35, v35
    v_exp_f32 v36, v36
    v_exp_f32 v37, v37
    v_mfma_f32_32x32x16_bf16 v[16:31], v[244:247], v[120:123], v[212:227]
    v_exp_f32 v38, v38
    v_exp_f32 v39, v39
    v_cvt_pk_bf16_f32 v48, v32, v33
    v_cvt_pk_bf16_f32 v49, v34, v35
    v_cvt_pk_bf16_f32 v50, v36, v37
    v_cvt_pk_bf16_f32 v51, v38, v39
    v_exp_f32 v40, v40
    v_exp_f32 v41, v41
    v_mfma_f32_32x32x16_bf16 v[128:143], v[228:231], v[48:51], v[128:143]
    s_sub_u32 s45, s94, 32768
    s_max_u32 s45, s45, s3
    buffer_load_dwordx4 v[108:111], v211, s[28:31], s45 offen sc1
    s_sub_u32 s45, s94, 32768
    s_max_u32 s45, s45, s3
    s_mov_b64 exec, s[60:61]
    buffer_load_dwordx4 v[112:115], v253, s[28:31], s45 offen sc1
    buffer_load_dwordx4 v[116:119], v253, s[28:31], s45 offen offset:512 sc1
    s_mov_b64 exec, -1
    v_exp_f32 v42, v42
    v_exp_f32 v43, v43
    v_exp_f32 v44, v44
    v_exp_f32 v45, v45
    v_exp_f32 v46, v46
    v_exp_f32 v47, v47
    v_cvt_pk_bf16_f32 v52, v40, v41
    v_cvt_pk_bf16_f32 v53, v42, v43
    v_cvt_pk_bf16_f32 v54, v44, v45
    v_cvt_pk_bf16_f32 v55, v46, v47
    v_exp_f32 v16, v16
    v_exp_f32 v17, v17
    v_mfma_f32_32x32x16_bf16 v[128:143], v[232:235], v[52:55], v[128:143]
    v_exp_f32 v18, v18
    v_exp_f32 v19, v19
    v_exp_f32 v20, v20
    v_exp_f32 v21, v21
    s_waitcnt vmcnt(9)
    s_cmp_le_u32 s55, 7
    s_cbranch_scc1 KV_6
    v_mov_b64 v[76:77], 0
    v_mov_b64 v[78:79], 0
    v_mov_b64 v[80:81], 0
    v_mov_b64 v[82:83], 0
    s_nop 1
KV_6:
    v_mfma_f32_32x32x16_bf16 v[32:47], v[72:75], v[124:127], 0
    v_exp_f32 v22, v22
    v_exp_f32 v23, v23
    v_cvt_pk_bf16_f32 v48, v16, v17
    v_cvt_pk_bf16_f32 v49, v18, v19
    v_cvt_pk_bf16_f32 v50, v20, v21
    v_cvt_pk_bf16_f32 v51, v22, v23
    v_exp_f32 v24, v24
    v_exp_f32 v25, v25
    v_mfma_f32_32x32x16_bf16 v[56:71], v[228:231], v[48:51], 0
    s_add_u32 m0, s63, 0
    s_add_u32 s45, s62, 0
    buffer_load_dwordx4 v254, s[12:15], s45 offen lds
    s_add_u32 m0, s63, 1024
    s_add_u32 s45, s62, 8192
    buffer_load_dwordx4 v254, s[12:15], s45 offen lds
    v_exp_f32 v26, v26
    v_exp_f32 v27, v27
    v_exp_f32 v28, v28
    v_exp_f32 v29, v29
    v_exp_f32 v30, v30
    v_exp_f32 v31, v31
    v_cvt_pk_bf16_f32 v52, v24, v25
    v_cvt_pk_bf16_f32 v53, v26, v27
    v_cvt_pk_bf16_f32 v54, v28, v29
    v_cvt_pk_bf16_f32 v55, v30, v31
    v_exp_f32 v32, v32
    v_exp_f32 v33, v33
    v_mfma_f32_32x32x16_bf16 v[56:71], v[232:235], v[52:55], v[56:71]
    v_exp_f32 v34, v34
    v_exp_f32 v35, v35
    v_exp_f32 v36, v36
    v_exp_f32 v37, v37
    s_waitcnt vmcnt(8)
    s_cmp_le_u32 s55, 6
    s_cbranch_scc1 KV_7
    v_mov_b64 v[88:89], 0
    v_mov_b64 v[90:91], 0
    v_mov_b64 v[92:93], 0
    v_mov_b64 v[94:95], 0
    s_nop 1
KV_7:
    v_mfma_f32_32x32x16_bf16 v[16:31], v[84:87], v[124:127], 0
    v_exp_f32 v38, v38
    v_exp_f32 v39, v39
    v_cvt_pk_bf16_f32 v48, v32, v33
    v_cvt_pk_bf16_f32 v49, v34, v35
    v_cvt_pk_bf16_f32 v50, v36, v37
    v_cvt_pk_bf16_f32 v51, v38, v39
    v_exp_f32 v40, v40
    v_exp_f32 v41, v41
    v_mfma_f32_32x32x16_bf16 v[128:143], v[76:79], v[48:51], v[128:143]
    s_add_u32 m0, s63, 2048
    s_add_u32 s45, s62, 16384
    buffer_load_dwordx4 v254, s[12:15], s45 offen lds
    s_add_u32 m0, s63, 3072
    s_add_u32 s45, s62, 24576
    buffer_load_dwordx4 v254, s[12:15], s45 offen lds
    v_exp_f32 v42, v42
    v_exp_f32 v43, v43
    v_exp_f32 v44, v44
    v_exp_f32 v45, v45
    v_exp_f32 v46, v46
    v_exp_f32 v47, v47
    v_cvt_pk_bf16_f32 v52, v40, v41
    v_cvt_pk_bf16_f32 v53, v42, v43
    v_cvt_pk_bf16_f32 v54, v44, v45
    v_cvt_pk_bf16_f32 v55, v46, v47
    v_exp_f32 v16, v16
    v_exp_f32 v17, v17
    v_mfma_f32_32x32x16_bf16 v[128:143], v[80:83], v[52:55], v[128:143]
    v_exp_f32 v18, v18
    v_exp_f32 v19, v19
    v_exp_f32 v20, v20
    v_exp_f32 v21, v21
    s_waitcnt vmcnt(7)
    s_cmp_le_u32 s55, 5
    s_cbranch_scc1 KV_8
    v_mov_b64 v[100:101], 0
    v_mov_b64 v[102:103], 0
    v_mov_b64 v[104:105], 0
    v_mov_b64 v[106:107], 0
    s_nop 1
KV_8:
    v_mfma_f32_32x32x16_bf16 v[32:47], v[96:99], v[124:127], 0
    v_exp_f32 v22, v22
    v_exp_f32 v23, v23
    v_cvt_pk_bf16_f32 v48, v16, v17
    v_cvt_pk_bf16_f32 v49, v18, v19
    v_cvt_pk_bf16_f32 v50, v20, v21
    v_cvt_pk_bf16_f32 v51, v22, v23
    v_exp_f32 v24, v24
    v_exp_f32 v25, v25
    v_mfma_f32_32x32x16_bf16 v[128:143], v[88:91], v[48:51], v[128:143]
    s_add_u32 m0, s63, 4096
    s_add_u32 s45, s62, 32768
    buffer_load_dwordx4 v254, s[12:15], s45 offen lds
    v_exp_f32 v26, v26
    v_exp_f32 v27, v27
    v_exp_f32 v28, v28
    v_exp_f32 v29, v29
    v_exp_f32 v30, v30
    v_exp_f32 v31, v31
    v_cvt_pk_bf16_f32 v52, v24, v25
    v_cvt_pk_bf16_f32 v53, v26, v27
    v_cvt_pk_bf16_f32 v54, v28, v29
    v_cvt_pk_bf16_f32 v55, v30, v31
    v_exp_f32 v32, v32
    v_exp_f32 v33, v33
    v_mfma_f32_32x32x16_bf16 v[128:143], v[92:95], v[52:55], v[128:143]
    v_exp_f32 v34, v34
    v_exp_f32 v35, v35
    v_exp_f32 v36, v36
    v_exp_f32 v37, v37
    s_waitcnt vmcnt(5)
    s_cmp_le_u32 s55, 4
    s_cbranch_scc1 KV_9
    v_mov_b64 v[112:113], 0
    v_mov_b64 v[114:115], 0
    v_mov_b64 v[116:117], 0
    v_mov_b64 v[118:119], 0
    s_nop 1
KV_9:
    v_mfma_f32_32x32x16_bf16 v[16:31], v[108:111], v[124:127], 0
    v_exp_f32 v38, v38
    v_exp_f32 v39, v39
    v_cvt_pk_bf16_f32 v48, v32, v33
    v_cvt_pk_bf16_f32 v49, v34, v35
    v_cvt_pk_bf16_f32 v50, v36, v37
    v_cvt_pk_bf16_f32 v51, v38, v39
    v_exp_f32 v40, v40
    v_exp_f32 v41, v41
    v_mfma_f32_32x32x16_bf16 v[128:143], v[100:103], v[48:51], v[128:143]
    s_add_u32 m0, s63, 5120
    s_add_u32 s45, s62, 40960
    buffer_load_dwordx4 v254, s[12:15], s45 offen lds
    v_exp_f32 v42, v42
    v_exp_f32 v43, v43
    v_exp_f32 v44, v44
    v_exp_f32 v45, v45
    v_exp_f32 v46, v46
    v_exp_f32 v47, v47
    v_cvt_pk_bf16_f32 v52, v40, v41
    v_cvt_pk_bf16_f32 v53, v42, v43
    v_cvt_pk_bf16_f32 v54, v44, v45
    v_cvt_pk_bf16_f32 v55, v46, v47
    v_exp_f32 v16, v16
    v_exp_f32 v17, v17
    v_mfma_f32_32x32x16_bf16 v[128:143], v[104:107], v[52:55], v[128:143]
    v_exp_f32 v18, v18
    v_exp_f32 v19, v19
    v_exp_f32 v20, v20
    v_exp_f32 v21, v21
    v_mfma_f32_32x32x16_bf16 v[32:47], v[72:75], v[120:123], 0
    v_exp_f32 v22, v22
    v_exp_f32 v23, v23
    v_cvt_pk_bf16_f32 v48, v16, v17
    v_cvt_pk_bf16_f32 v49, v18, v19
    v_cvt_pk_bf16_f32 v50, v20, v21
    v_cvt_pk_bf16_f32 v51, v22, v23
    v_exp_f32 v24, v24
    v_exp_f32 v25, v25
    v_mfma_f32_32x32x16_bf16 v[128:143], v[112:115], v[48:51], v[128:143]
    s_add_u32 m0, s63, 6144
    s_add_u32 s45, s62, 49152
    buffer_load_dwordx4 v254, s[12:15], s45 offen lds
    v_exp_f32 v26, v26
    v_exp_f32 v27, v27
    v_exp_f32 v28, v28
    v_exp_f32 v29, v29
    v_exp_f32 v30, v30
    v_exp_f32 v31, v31
    v_cvt_pk_bf16_f32 v52, v24, v25
    v_cvt_pk_bf16_f32 v53, v26, v27
    v_cvt_pk_bf16_f32 v54, v28, v29
    v_cvt_pk_bf16_f32 v55, v30, v31
    v_exp_f32 v32, v32
    v_exp_f32 v33, v33
    v_mfma_f32_32x32x16_bf16 v[128:143], v[116:119], v[52:55], v[128:143]
    v_exp_f32 v34, v34
    v_exp_f32 v35, v35
    v_exp_f32 v36, v36
    v_exp_f32 v37, v37
    v_mfma_f32_32x32x16_bf16 v[16:31], v[84:87], v[120:123], 0
    v_exp_f32 v38, v38
    v_exp_f32 v39, v39
    v_cvt_pk_bf16_f32 v48, v32, v33
    v_cvt_pk_bf16_f32 v49, v34, v35
    v_cvt_pk_bf16_f32 v50, v36, v37
    v_cvt_pk_bf16_f32 v51, v38, v39
    v_exp_f32 v40, v40
    v_exp_f32 v41, v41
    v_mfma_f32_32x32x16_bf16 v[56:71], v[76:79], v[48:51], v[56:71]
    s_add_u32 m0, s63, 7168
    s_add_u32 s45, s62, 57344
    buffer_load_dwordx4 v254, s[12:15], s45 offen lds
    v_lshl_add_u32 v188, v1, 2, v255
    v_mov_b32 v189, 68624
    ds_write_b128 v252, v[128:131] offset:0
    ds_write_b128 v252, v[132:135] offset:1024
    ds_write_b32 v188, v136 offset:256
    ds_write_b32 v255, v189 offset:4
    v_exp_f32 v42, v42
    v_exp_f32 v43, v43
    v_exp_f32 v44, v44
    v_exp_f32 v45, v45
    v_exp_f32 v46, v46
    v_exp_f32 v47, v47
    v_cvt_pk_bf16_f32 v52, v40, v41
    v_cvt_pk_bf16_f32 v53, v42, v43
    v_cvt_pk_bf16_f32 v54, v44, v45
    v_cvt_pk_bf16_f32 v55, v46, v47
    v_exp_f32 v16, v16
    v_exp_f32 v17, v17
    v_mfma_f32_32x32x16_bf16 v[56:71], v[80:83], v[52:55], v[56:71]
    v_exp_f32 v18, v18
    v_exp_f32 v19, v19
    v_exp_f32 v20, v20
    v_exp_f32 v21, v21
    v_mfma_f32_32x32x16_bf16 v[32:47], v[96:99], v[120:123], 0
    v_exp_f32 v22, v22
    v_exp_f32 v23, v23
    v_cvt_pk_bf16_f32 v48, v16, v17
    v_cvt_pk_bf16_f32 v49, v18, v19
    v_cvt_pk_bf16_f32 v50, v20, v21
    v_cvt_pk_bf16_f32 v51, v22, v23
    v_exp_f32 v24, v24
    v_exp_f32 v25, v25
    v_mfma_f32_32x32x16_bf16 v[56:71], v[88:91], v[48:51], v[56:71]
    v_exp_f32 v26, v26
    v_exp_f32 v27, v27
    v_exp_f32 v28, v28
    v_exp_f32 v29, v29
    v_exp_f32 v30, v30
    v_exp_f32 v31, v31
    v_cvt_pk_bf16_f32 v52, v24, v25
    v_cvt_pk_bf16_f32 v53, v26, v27
    v_cvt_pk_bf16_f32 v54, v28, v29
    v_cvt_pk_bf16_f32 v55, v30, v31
    v_exp_f32 v32, v32
    v_exp_f32 v33, v33
    v_mfma_f32_32x32x16_bf16 v[56:71], v[92:95], v[52:55], v[56:71]
    v_exp_f32 v34, v34
    v_exp_f32 v35, v35
    v_exp_f32 v36, v36
    v_exp_f32 v37, v37
    v_mfma_f32_32x32x16_bf16 v[16:31], v[108:111], v[120:123], 0
    v_exp_f32 v38, v38
    v_exp_f32 v39, v39
    v_cvt_pk_bf16_f32 v48, v32, v33
    v_cvt_pk_bf16_f32 v49, v34, v35
    v_cvt_pk_bf16_f32 v50, v36, v37
    v_cvt_pk_bf16_f32 v51, v38, v39
    v_exp_f32 v40, v40
    v_exp_f32 v41, v41
    v_mfma_f32_32x32x16_bf16 v[56:71], v[100:103], v[48:51], v[56:71]
    v_exp_f32 v42, v42
    v_exp_f32 v43, v43
    v_exp_f32 v44, v44
    v_exp_f32 v45, v45
    v_exp_f32 v46, v46
    v_exp_f32 v47, v47
    v_cvt_pk_bf16_f32 v52, v40, v41
    v_cvt_pk_bf16_f32 v53, v42, v43
    v_cvt_pk_bf16_f32 v54, v44, v45
    v_cvt_pk_bf16_f32 v55, v46, v47
    v_exp_f32 v16, v16
    v_exp_f32 v17, v17
    v_mfma_f32_32x32x16_bf16 v[56:71], v[104:107], v[52:55], v[56:71]
    v_exp_f32 v18, v18
    v_exp_f32 v19, v19
    v_exp_f32 v20, v20
    v_exp_f32 v21, v21
    v_exp_f32 v22, v22
    v_exp_f32 v23, v23
    v_cvt_pk_bf16_f32 v48, v16, v17
    v_cvt_pk_bf16_f32 v49, v18, v19
    v_cvt_pk_bf16_f32 v50, v20, v21
    v_cvt_pk_bf16_f32 v51, v22, v23
    v_exp_f32 v24, v24
    v_exp_f32 v25, v25
    v_mfma_f32_32x32x16_bf16 v[56:71], v[112:115], v[48:51], v[56:71]
    ds_read_b32 v185, v255 offset:8
    ds_read_b32 v184, v188 offset:512
    ds_read_b128 v[176:179], v252 offset:2048
    ds_read_b128 v[180:183], v252 offset:3072
    ds_read_b32 v186, v189
    ds_read_b32 v187, v255
    v_exp_f32 v26, v26
    v_exp_f32 v27, v27
    v_exp_f32 v28, v28
    v_exp_f32 v29, v29
    v_exp_f32 v30, v30
    v_exp_f32 v31, v31
    v_cvt_pk_bf16_f32 v52, v24, v25
    v_cvt_pk_bf16_f32 v53, v26, v27
    v_cvt_pk_bf16_f32 v54, v28, v29
    v_cvt_pk_bf16_f32 v55, v30, v31
    s_nop 1
    v_mfma_f32_32x32x16_bf16 v[56:71], v[116:119], v[52:55], v[56:71]
    s_mov_b32 s44, 200000
XW_10:
    s_waitcnt lgkmcnt(0)
    v_readfirstlane_b32 s45, v185
    v_readfirstlane_b32 s48, v187
    v_readfirstlane_b32 s41, v186
    s_min_u32 s45, s45, s48
    s_cmp_ge_u32 s45, 8
    s_cbranch_scc1 XD_11
    ds_read_b32 v185, v255 offset:8
    ds_read_b32 v184, v188 offset:512
    ds_read_b128 v[176:179], v252 offset:2048
    ds_read_b128 v[180:183], v252 offset:3072
    ds_read_b32 v186, v189
    ds_read_b32 v187, v255
    s_sub_u32 s44, s44, 1
    s_cbranch_scc0 XW_10
    s_waitcnt lgkmcnt(0)
XD_11:
    s_mov_b32 s45, 0x30800000
    s_mov_b32 s48, 0x4e800000
    s_nop 1
    v_add_f32 v64, v64, v184
    v_rcp_f32 v66, v64
    v_cmp_nlt_f32 vcc, s45, v64
    v_cmp_ngt_f32 s[50:51], s48, v64
    v_pk_add_f32 v[56:57], v[56:57], v[176:177]
    v_pk_add_f32 v[58:59], v[58:59], v[178:179]
    v_pk_add_f32 v[60:61], v[60:61], v[180:181]
    v_pk_add_f32 v[62:63], v[62:63], v[182:183]
    s_or_b64 vcc, vcc, s[50:51]
    s_cbranch_vccnz L_SLOW
L_ATTNORM0:
    v_pk_mul_f32 v[56:57], v[56:57], v[66:67] op_sel_hi:[1,0]
    v_pk_mul_f32 v[58:59], v[58:59], v[66:67] op_sel_hi:[1,0]
    v_pk_mul_f32 v[60:61], v[60:61], v[66:67] op_sel_hi:[1,0]
    v_pk_mul_f32 v[62:63], v[62:63], v[66:67] op_sel_hi:[1,0]
    v_cvt_pk_bf16_f32 v48, v56, v57
    v_cvt_pk_bf16_f32 v49, v58, v59
    v_cvt_pk_bf16_f32 v50, v60, v61
    v_cvt_pk_bf16_f32 v51, v62, v63
    s_cmp_eq_u32 s41, 0
    s_cbranch_scc1 L_OGLOB0
    buffer_store_dwordx4 v[48:51], v211, s[28:31], s57 offen nt
L_OST0:
    v_add_u32 v19, s92, v211
    v_mov_b32 v16, s42
    v_mov_b32 v17, s43
    v_mov_b32 v18, 0
    ds_write_b128 v19, v[48:51]
    s_waitcnt vmcnt(0)
    s_mov_b64 exec, 1
    s_cmp_eq_u32 s41, 0
    s_cbranch_scc1 L_FGLOB0
    buffer_store_dwordx2 v[16:17], v18, s[28:31], s93 offen
L_ODONE0:
    s_mov_b64 exec, -1
    s_waitcnt lgkmcnt(0)
    s_barrier
    s_mov_b32 s32, s84
    s_and_b32 s33, s85, 0xffff
    s_mov_b32 s34, 2097152
    s_mov_b32 s35, 0x20000
    s_mov_b32 s48, 0xbfb8aa3b
    v_add_f32 v208, v208, v209
    v_mul_f32 v208, s48, v208
    v_exp_f32 v208, v208
    ds_read_b64_tr_b16 v[72:73], v8 offset:0
    ds_read_b64_tr_b16 v[74:75], v8 offset:1024
    v_add_f32 v208, 1.0, v208
    s_nop 0
    ds_read_b64_tr_b16 v[76:77], v8 offset:2048
    ds_read_b64_tr_b16 v[78:79], v8 offset:3072
    v_rcp_f32 v208, v208
    s_nop 0
    ds_read_b64_tr_b16 v[104:105], v8 offset:16384
    ds_read_b64_tr_b16 v[106:107], v8 offset:17408
    v_sub_f32 v26, 1.0, v208
    s_nop 0
    ds_read_b64_tr_b16 v[108:109], v8 offset:18432
    ds_read_b64_tr_b16 v[110:111], v8 offset:19456
    v_lshlrev_b32 v212, 16, v200
    v_mul_f32 v212, v212, v26
    ds_read_b64_tr_b16 v[136:137], v8 offset:32768
    ds_read_b64_tr_b16 v[138:139], v8 offset:33792
    v_and_b32 v213, 0xffff0000, v200
    v_mul_f32 v213, v213, v26
    ds_read_b64_tr_b16 v[140:141], v8 offset:34816
    ds_read_b64_tr_b16 v[142:143], v8 offset:35840
    v_lshlrev_b32 v214, 16, v201
    v_mul_f32 v214, v214, v26
    ds_read_b64_tr_b16 v[168:169], v8 offset:49152
    ds_read_b64_tr_b16 v[170:171], v8 offset:50176
    v_and_b32 v215, 0xffff0000, v201
    v_mul_f32 v215, v215, v26
    ds_read_b64_tr_b16 v[172:173], v8 offset:51200
    ds_read_b64_tr_b16 v[174:175], v8 offset:52224
    v_lshlrev_b32 v216, 16, v202
    v_mul_f32 v216, v216, v26
    ds_read_b64_tr_b16 v[80:81], v8 offset:4096
    ds_read_b64_tr_b16 v[82:83], v8 offset:5120
    v_and_b32 v217, 0xffff0000, v202
    v_mul_f32 v217, v217, v26
    ds_read_b64_tr_b16 v[84:85], v8 offset:6144
    ds_read_b64_tr_b16 v[86:87], v8 offset:7168
    v_lshlrev_b32 v218, 16, v203
    v_mul_f32 v218, v218, v26
    ds_read_b64_tr_b16 v[112:113], v8 offset:20480
    ds_read_b64_tr_b16 v[114:115], v8 offset:21504
    v_and_b32 v219, 0xffff0000, v203
    v_mul_f32 v219, v219, v26
    ds_read_b64_tr_b16 v[116:117], v8 offset:22528
    ds_read_b64_tr_b16 v[118:119], v8 offset:23552
    v_lshlrev_b32 v220, 16, v204
    v_mul_f32 v220, v220, v26
    ds_read_b64_tr_b16 v[144:145], v8 offset:36864
    ds_read_b64_tr_b16 v[146:147], v8 offset:37888
    v_and_b32 v221, 0xffff0000, v204
    v_mul_f32 v221, v221, v26
    ds_read_b64_tr_b16 v[148:149], v8 offset:38912
    ds_read_b64_tr_b16 v[150:151], v8 offset:39936
    v_lshlrev_b32 v222, 16, v205
    v_mul_f32 v222, v222, v26
    ds_read_b64_tr_b16 v[176:177], v8 offset:53248
    ds_read_b64_tr_b16 v[178:179], v8 offset:54272
    v_and_b32 v223, 0xffff0000, v205
    v_mul_f32 v223, v223, v26
    ds_read_b64_tr_b16 v[180:181], v8 offset:55296
    ds_read_b64_tr_b16 v[182:183], v8 offset:56320
    v_lshlrev_b32 v224, 16, v206
    v_mul_f32 v224, v224, v26
    ds_read_b64_tr_b16 v[88:89], v8 offset:8192
    ds_read_b64_tr_b16 v[90:91], v8 offset:9216
    v_and_b32 v225, 0xffff0000, v206
    v_mul_f32 v225, v225, v26
    ds_read_b64_tr_b16 v[92:93], v8 offset:10240
    ds_read_b64_tr_b16 v[94:95], v8 offset:11264
    v_lshlrev_b32 v226, 16, v207
    v_mul_f32 v226, v226, v26
    ds_read_b64_tr_b16 v[120:121], v8 offset:24576
    ds_read_b64_tr_b16 v[122:123], v8 offset:25600
    v_and_b32 v227, 0xffff0000, v207
    v_mul_f32 v227, v227, v26
    ds_read_b64_tr_b16 v[124:125], v8 offset:26624
    ds_read_b64_tr_b16 v[126:127], v8 offset:27648
    ds_read_b64_tr_b16 v[152:153], v8 offset:40960
    ds_read_b64_tr_b16 v[154:155], v8 offset:41984
    ds_read_b64_tr_b16 v[156:157], v8 offset:43008
    ds_read_b64_tr_b16 v[158:159], v8 offset:44032
    ds_read_b64_tr_b16 v[184:185], v8 offset:57344
    ds_read_b64_tr_b16 v[186:187], v8 offset:58368
    ds_read_b64_tr_b16 v[188:189], v8 offset:59392
    ds_read_b64_tr_b16 v[190:191], v8 offset:60416
    ds_read_b64_tr_b16 v[96:97], v8 offset:12288
    ds_read_b64_tr_b16 v[98:99], v8 offset:13312
    ds_read_b64_tr_b16 v[100:101], v8 offset:14336
    ds_read_b64_tr_b16 v[102:103], v8 offset:15360
    ds_read_b64_tr_b16 v[128:129], v8 offset:28672
    ds_read_b64_tr_b16 v[130:131], v8 offset:29696
    ds_read_b64_tr_b16 v[132:133], v8 offset:30720
    ds_read_b64_tr_b16 v[134:135], v8 offset:31744
    ds_read_b64_tr_b16 v[160:161], v8 offset:45056
    ds_read_b64_tr_b16 v[162:163], v8 offset:46080
    ds_read_b64_tr_b16 v[164:165], v8 offset:47104
    ds_read_b64_tr_b16 v[166:167], v8 offset:48128
    ds_read_b64_tr_b16 v[192:193], v8 offset:61440
    ds_read_b64_tr_b16 v[194:195], v8 offset:62464
    ds_read_b64_tr_b16 v[196:197], v8 offset:63488
    ds_read_b64_tr_b16 v[198:199], v8 offset:64512
    s_barrier
    ds_read_b128 v[28:31], v10 offset:0
    ds_read_b128 v[32:35], v10 offset:1024
    ds_read_b128 v[36:39], v10 offset:16384
    ds_read_b128 v[40:43], v10 offset:17408
    ds_read_b128 v[44:47], v10 offset:32768
    ds_read_b128 v[48:51], v10 offset:33792
    ds_read_b128 v[52:55], v10 offset:49152
    ds_read_b128 v[56:59], v10 offset:50176
    s_waitcnt lgkmcnt(7)
    v_mfma_f32_32x32x16_bf16 v[228:243], v[72:75], v[28:31], 0
    s_waitcnt lgkmcnt(6)
    v_mfma_f32_32x32x16_bf16 v[228:243], v[76:79], v[32:35], v[228:243]
    s_waitcnt lgkmcnt(5)
    v_mfma_f32_32x32x16_bf16 v[228:243], v[104:107], v[36:39], v[228:243]
    s_waitcnt lgkmcnt(4)
    v_mfma_f32_32x32x16_bf16 v[228:243], v[108:111], v[40:43], v[228:243]
    s_waitcnt lgkmcnt(0)
    s_barrier
    v_mfma_f32_32x32x16_bf16 v[228:243], v[136:139], v[44:47], v[228:243]
    ds_read_b128 v[60:63], v10 offset:2048
    ds_read_b128 v[64:67], v10 offset:3072
    ds_read_b128 v[68:71], v10 offset:18432
    v_mfma_f32_32x32x16_bf16 v[228:243], v[140:143], v[48:51], v[228:243]
    ds_read_b128 v[244:247], v10 offset:19456
    ds_read_b128 v[248:251], v10 offset:34816
    ds_read_b128 v[252:255], v10 offset:35840
    v_mfma_f32_32x32x16_bf16 v[228:243], v[168:171], v[52:55], v[228:243]
    ds_read_b128 v[4:7], v10 offset:51200
    ds_read_b128 v[12:15], v10 offset:52224
    v_mfma_f32_32x32x16_bf16 v[228:243], v[172:175], v[56:59], v[228:243]
    s_waitcnt lgkmcnt(7)
    v_mfma_f32_32x32x16_bf16 v[228:243], v[80:83], v[60:63], v[228:243]
    s_waitcnt lgkmcnt(6)
    v_mfma_f32_32x32x16_bf16 v[228:243], v[84:87], v[64:67], v[228:243]
    s_waitcnt lgkmcnt(5)
    v_mfma_f32_32x32x16_bf16 v[228:243], v[112:115], v[68:71], v[228:243]
    s_waitcnt lgkmcnt(4)
    v_mfma_f32_32x32x16_bf16 v[228:243], v[116:119], v[244:247], v[228:243]
    s_waitcnt lgkmcnt(0)
    s_barrier
    v_mfma_f32_32x32x16_bf16 v[228:243], v[144:147], v[248:251], v[228:243]
    ds_read_b128 v[28:31], v10 offset:8192
    ds_read_b128 v[32:35], v10 offset:9216
    ds_read_b128 v[36:39], v10 offset:24576
    v_mfma_f32_32x32x16_bf16 v[228:243], v[148:151], v[252:255], v[228:243]
    ds_read_b128 v[40:43], v10 offset:25600
    ds_read_b128 v[44:47], v10 offset:40960
    ds_read_b128 v[48:51], v10 offset:41984
    v_mfma_f32_32x32x16_bf16 v[228:243], v[176:179], v[4:7], v[228:243]
    ds_read_b128 v[52:55], v10 offset:57344
    ds_read_b128 v[56:59], v10 offset:58368
    v_mfma_f32_32x32x16_bf16 v[228:243], v[180:183], v[12:15], v[228:243]
    s_waitcnt lgkmcnt(7)
    v_mfma_f32_32x32x16_bf16 v[228:243], v[88:91], v[28:31], v[228:243]
    s_waitcnt lgkmcnt(6)
    v_mfma_f32_32x32x16_bf16 v[228:243], v[92:95], v[32:35], v[228:243]
    s_waitcnt lgkmcnt(5)
    v_mfma_f32_32x32x16_bf16 v[228:243], v[120:123], v[36:39], v[228:243]
    s_waitcnt lgkmcnt(4)
    v_mfma_f32_32x32x16_bf16 v[228:243], v[124:127], v[40:43], v[228:243]
    s_waitcnt lgkmcnt(0)
    s_barrier
    v_mfma_f32_32x32x16_bf16 v[228:243], v[152:155], v[44:47], v[228:243]
    ds_read_b128 v[60:63], v10 offset:10240
    ds_read_b128 v[64:67], v10 offset:11264
    ds_read_b128 v[68:71], v10 offset:26624
    v_mfma_f32_32x32x16_bf16 v[228:243], v[156:159], v[48:51], v[228:243]
    ds_read_b128 v[244:247], v10 offset:27648
    ds_read_b128 v[248:251], v10 offset:43008
    ds_read_b128 v[252:255], v10 offset:44032
    v_mfma_f32_32x32x16_bf16 v[228:243], v[184:187], v[52:55], v[228:243]
    ds_read_b128 v[4:7], v10 offset:59392
    ds_read_b128 v[12:15], v10 offset:60416
    v_mfma_f32_32x32x16_bf16 v[228:243], v[188:191], v[56:59], v[228:243]
    s_waitcnt lgkmcnt(7)
    v_mfma_f32_32x32x16_bf16 v[228:243], v[96:99], v[60:63], v[228:243]
    s_waitcnt lgkmcnt(6)
    v_mfma_f32_32x32x16_bf16 v[228:243], v[100:103], v[64:67], v[228:243]
    s_waitcnt lgkmcnt(5)
    v_mfma_f32_32x32x16_bf16 v[228:243], v[128:131], v[68:71], v[228:243]
    s_waitcnt lgkmcnt(4)
    v_mfma_f32_32x32x16_bf16 v[228:243], v[132:135], v[244:247], v[228:243]
    s_waitcnt lgkmcnt(0)
    s_barrier
    v_mfma_f32_32x32x16_bf16 v[228:243], v[160:163], v[248:251], v[228:243]
    ds_read_b64_tr_b16 v[16:17], v9 offset:0
    ds_read_b64_tr_b16 v[18:19], v9 offset:512
    ds_read_b64_tr_b16 v[20:21], v9 offset:1024
    ds_read_b64_tr_b16 v[22:23], v9 offset:1536
    v_mfma_f32_32x32x16_bf16 v[228:243], v[164:167], v[252:255], v[228:243]
    v_mfma_f32_32x32x16_bf16 v[228:243], v[192:195], v[4:7], v[228:243]
    s_waitcnt lgkmcnt(0)
    v_lshlrev_b32 v27, 16, v16
    v_mul_f32 v212, v212, v27
    v_and_b32 v27, 0xffff0000, v16
    v_mul_f32 v213, v213, v27
    v_lshlrev_b32 v27, 16, v17
    v_mul_f32 v214, v214, v27
    v_mfma_f32_32x32x16_bf16 v[228:243], v[196:199], v[12:15], v[228:243]
    v_and_b32 v27, 0xffff0000, v17
    v_mul_f32 v215, v215, v27
    v_lshlrev_b32 v27, 16, v18
    v_mul_f32 v216, v216, v27
    v_and_b32 v27, 0xffff0000, v18
    v_mul_f32 v217, v217, v27
    v_lshlrev_b32 v27, 16, v19
    v_mul_f32 v218, v218, v27
    v_and_b32 v27, 0xffff0000, v19
    v_mul_f32 v219, v219, v27
    v_lshlrev_b32 v27, 16, v20
    v_mul_f32 v220, v220, v27
    v_and_b32 v27, 0xffff0000, v20
    v_mul_f32 v221, v221, v27
    v_lshlrev_b32 v27, 16, v21
    v_mul_f32 v222, v222, v27
    v_and_b32 v27, 0xffff0000, v21
    v_mul_f32 v223, v223, v27
    v_lshlrev_b32 v27, 16, v22
    v_mul_f32 v224, v224, v27
    v_and_b32 v27, 0xffff0000, v22
    v_mul_f32 v225, v225, v27
    v_lshlrev_b32 v27, 16, v23
    v_mul_f32 v226, v226, v27
    v_and_b32 v27, 0xffff0000, v23
    v_mul_f32 v227, v227, v27
    v_fmac_f32 v212, v208, v228
    v_fmac_f32 v213, v208, v229
    v_fmac_f32 v214, v208, v230
    v_fmac_f32 v215, v208, v231
    v_fmac_f32 v216, v208, v232
    v_fmac_f32 v217, v208, v233
    v_fmac_f32 v218, v208, v234
    v_fmac_f32 v219, v208, v235
    v_fmac_f32 v220, v208, v236
    v_fmac_f32 v221, v208, v237
    v_fmac_f32 v222, v208, v238
    v_fmac_f32 v223, v208, v239
    v_fmac_f32 v224, v208, v240
    v_fmac_f32 v225, v208, v241
    v_fmac_f32 v226, v208, v242
    v_fmac_f32 v227, v208, v243
    v_cvt_pk_bf16_f32 v28, v212, v213
    v_cvt_pk_bf16_f32 v29, v214, v215
    v_cvt_pk_bf16_f32 v30, v216, v217
    v_cvt_pk_bf16_f32 v31, v218, v219
    v_cvt_pk_bf16_f32 v32, v220, v221
    v_cvt_pk_bf16_f32 v33, v222, v223
    v_cvt_pk_bf16_f32 v34, v224, v225
    v_cvt_pk_bf16_f32 v35, v226, v227
    v_permlane16_swap_b32 v28, v32
    v_permlane16_swap_b32 v29, v33
    v_permlane16_swap_b32 v30, v34
    v_permlane16_swap_b32 v31, v35
    buffer_store_dwordx4 v[28:31], v11, s[32:35], s70 offen nt
    buffer_store_dwordx4 v[32:35], v11, s[32:35], s71 offen nt
    s_endpgm
L_LOADER:
    s_sub_u32 s16, s36, 4
    v_lshrrev_b32 v10, 4, v1
    v_xor_b32 v11, v9, v10
    v_lshlrev_b32 v12, 10, v8
    v_lshl_add_u32 v4, v11, 4, v12
    v_xor_b32 v5, 64, v4
    v_and_b32 v10, 1, v10
    v_lshlrev_b32 v10, 2, v10
    v_xor_b32 v10, v9, v10
    v_mul_u32_u24 v6, 3072, v8
    v_lshl_add_u32 v6, v10, 4, v6
    s_lshl_b32 s19, s37, 16
    s_lshl_b32 s45, s16, 14
    s_add_u32 s19, s19, s45
    s_mul_i32 s20, s16, 49152
    s_lshl_b32 s45, s38, 7
    s_add_u32 s20, s20, s45
    s_add_u32 s20, s20, 1024
    s_mul_i32 s21, s16, 6144
    s_lshl_b32 s22, s16, 11
    s_waitcnt lgkmcnt(0)
    s_mov_b32 s4, s64
    s_and_b32 s5, s65, 0xffff
    s_mov_b32 s6, 2097152
    s_mov_b32 s7, 0x20000
    s_mov_b32 s8, s66
    s_and_b32 s9, s67, 0xffff
    s_mov_b32 s10, 1572864
    s_mov_b32 s11, 0x20000
    s_barrier
    s_lshl_b32 s45, s90, 7
    s_add_u32 s45, s45, s19
    s_mul_i32 s48, s90, 196608
    s_add_u32 s48, s48, s20
    s_add_u32 m0, s21, 0
    s_add_u32 s49, s45, 8192
    buffer_load_dwordx4 v4, s[4:7], s45 offen lds
    s_add_u32 m0, s21, 1024
    s_add_u32 s50, s48, 24576
    buffer_load_dwordx4 v5, s[4:7], s49 offen lds
    s_add_u32 m0, s21, 2048
    s_add_u32 s90, s90, 1
    buffer_load_dwordx4 v6, s[8:11], s48 offen lds
    buffer_load_dwordx4 v6, s[8:11], s48 offen offset:1024 lds
    s_add_u32 m0, s21, 4096
    s_and_b32 s90, s90, 7
    buffer_load_dwordx4 v6, s[8:11], s50 offen lds
    buffer_load_dwordx4 v6, s[8:11], s50 offen offset:1024 lds
    v_mov_b32 v66, 0
    s_and_b32 s17, s16, 1
    s_lshr_b32 s52, s16, 1
    s_lshl_b32 s45, s39, 6
    s_lshl_b32 s48, s40, 1
    s_add_u32 s18, s45, s48
    s_lshl_b32 s45, s18, 1
    s_load_dword s78, s[80:81], s45
    s_add_u32 s18, s18, s52
    s_lshl_b32 s45, s18, 12
    s_lshl_b32 s48, s17, 11
    s_add_u32 s23, s45, s48
    s_mul_i32 s45, s52, 8320
    s_add_u32 s45, s45, s48
    s_add_u32 s45, s45, 98368
    v_add_u32 v62, s45, v211
    s_mov_b32 s28, s88
    s_and_b32 s29, s89, 0xffff
    s_mov_b32 s30, 16777216
    s_mov_b32 s31, 0x20000
    v_and_b32 v10, 15, v1
    v_lshrrev_b32 v11, 4, v1
    v_and_b32 v12, 1, v11
    v_mul_u32_u24 v27, 4160, v12
    v_lshl_add_u32 v27, v10, 2, v27
    s_mul_i32 s33, s16, 4160
    s_add_u32 s33, s33, 98368
    s_sub_u32 s49, s33, 64
    v_add_u32 v27, s49, v27
    ds_write_b32 v27, v66
    s_mul_i32 s32, s52, 4608
    s_lshl_b32 s48, s17, 8
    s_add_u32 s45, s32, s48
    s_add_u32 s45, s45, 135680
    v_lshl_add_u32 v31, v1, 2, s45
    ds_write_b32 v31, v66
    s_lshl_b32 s45, s16, 7
    s_add_u32 s35, s45, 140800
    v_lshl_add_u32 v31, v10, 2, s35
    ds_write_b32 v31, v66
    v_add_u32 v31, 1, v10
    v_and_b32 v67, 1, v31
    v_mul_u32_u24 v67, 4160, v67
    v_and_b32 v68, 30, v31
    v_lshl_add_u32 v68, v11, 3, v68
    v_lshl_add_u32 v67, v68, 1, v67
    s_mul_i32 s44, s52, 8320
    s_add_u32 s44, s44, 98368
    s_add_u32 s45, s44, s48
    v_add_u32 v16, s45, v67
    v_add_u32 v17, 1024, v16
    v_add_u32 v18, 2048, v16
    v_add_u32 v19, 3072, v16
    v_lshlrev_b32 v67, 5, v10
    v_lshlrev_b32 v69, 4, v11
    v_sub_u32 v68, v69, v67
    s_add_u32 s49, s32, s48
    s_add_u32 s49, s49, 132096
    v_add_u32 v201, s49, v68
    v_and_b32 v68, 16, v69
    v_sub_u32 v68, v68, v67
    s_lshl_b32 s48, s17, 11
    s_sub_u32 s45, s32, s48
    s_add_u32 s45, s45, 134112
    v_add_u32 v202, s45, v68
    s_add_u32 s32, s32, s48
    s_add_u32 s32, s32, 131584
    v_lshl_add_u32 v68, v12, 3, v31
    v_lshlrev_b32 v68, 1, v68
    s_sub_u32 s44, s44, 32
    v_mov_b32 v69, s44
    v_mov_b32 v70, s35
    v_cmp_gt_u32 vcc, 32, v1
    v_lshl_add_u32 v208, v11, 3, v67
    s_and_b32 s45, s18, 63
    v_cndmask_b32 v69, v70, v69, vcc
    v_add_u32 v203, v69, v68
    s_lshr_b32 s45, s45, 4
    s_lshl_b32 s48, s39, 2
    s_add_u32 s45, s45, s48
    s_lshl_b32 s45, s45, 10
    s_add_u32 s34, s45, 10616832
    v_and_b32 v68, 31, v1
    v_lshlrev_b32 v209, 5, v68
    v_lshlrev_b32 v23, 5, v68
    v_lshl_add_u32 v61, v68, 2, s35
    v_add_u32 v61, 512, v61
    v_mul_u32_u24 v67, 6144, v12
    v_lshl_add_u32 v67, v10, 7, v67
    s_mul_i32 s45, s17, 12288
    v_add_u32 v67, s45, v67
    v_lshrrev_b32 v69, 5, v1
    v_lshrrev_b32 v68, 1, v10
    v_xor_b32 v68, v68, v69
    s_lshl_b32 s45, s52, 2
    v_xor_b32 v68, s45, v68
    v_lshl_add_u32 v56, v68, 4, v67
    v_xor_b32 v57, 32, v56
    v_add_u32 v58, 49152, v56
    v_add_u32 v59, 49152, v57
    s_lshl_b32 s45, s52, 6
    s_add_u32 s45, s45, 141824
    v_lshl_add_u32 v60, v69, 4, s45
    s_lshl_b32 s45, s16, 12
    s_add_u32 s45, s45, 147456
    v_add_u32 v12, s45, v211
    v_xor_b32 v13, 4096, v12
    s_lshl_b32 s45, s16, 10
    s_add_u32 s45, s45, 73728
    v_add_u32 v14, s45, v211
    v_min_u32 v15, 3, v1
    v_mul_u32_u24 v15, 768, v15
    v_add_u32 v15, 65536, v15
    s_lshl_b32 s59, s39, 5
    s_add_u32 s59, s59, s40
    s_lshl_b32 s59, s59, 2
    s_add_u32 s59, s59, s16
    s_lshl_b32 s59, s59, 5
    s_add_u32 s59, s59, 10878976
    s_mov_b32 s26, 17
    s_mov_b32 s27, s26
    v_mov_b64 v[48:49], 0
    v_mov_b64 v[50:51], 0
    v_mov_b64 v[52:53], 0
    v_mov_b64 v[54:55], 0
    s_and_b32 s53, s36, 3
    s_lshr_b32 s54, s36, 2
    s_mov_b32 s60, 0x0000ffff
    s_mov_b32 s61, 0x0000ffff
    v_and_b32 v253, 15, v1
    v_lshlrev_b32 v253, 4, v253
    v_lshrrev_b32 v21, 5, v1
    v_lshl_add_u32 v253, v21, 8, v253
    v_add_u32 v253, 1024, v253
    s_lshl_b32 s45, s53, 12
    s_add_u32 s45, s45, 81920
    v_add_u32 v252, s45, v211
    v_lshrrev_b32 v254, 3, v1
    v_lshlrev_b32 v254, 10, v254
    v_lshrrev_b32 v21, 2, v1
    v_and_b32 v7, 3, v21
    v_and_b32 v21, 4, v21
    v_and_b32 v22, 7, v1
    v_xor_b32 v21, v21, v22
    v_lshl_add_u32 v254, v21, 4, v254
    s_lshl_b32 s48, s53, 11
    s_mul_i32 s45, s53, 768
    s_add_u32 s45, s45, 65536
    v_mov_b32 v255, s45
    s_max_u32 s45, s37, 1
    s_sub_u32 s45, s45, 1
    v_min_u32 v7, s45, v7
    v_sub_u32 v7, 3, v7
    v_lshlrev_b32 v7, 5, v7
    v_and_b32 v22, 3, v1
    v_lshl_add_u32 v7, v22, 3, v7
    s_lshl_b32 s49, s38, 5
    s_add_u32 s49, s49, s37
    s_lshl_b32 s45, s49, 5
    s_add_u32 s56, s45, 10747776
    s_lshl_b32 s94, s49, 14
    s_add_u32 s94, s94, s48
    s_add_u32 s94, s94, 12582912
    s_lshl_b32 s3, s37, 14
    s_sub_u32 s3, s94, s3
    s_lshl_b32 s55, s37, 1
    s_sub_u32 s55, 8, s55
    s_max_i32 s55, s55, 0
    s_lshl_b32 s57, s37, 3
    s_add_u32 s57, s57, s38
    s_lshl_b32 s57, s57, 3
    s_add_u32 s57, s57, s36
    s_lshl_b32 s57, s57, 10
    s_add_u32 s57, s57, 6291456
    s_lshl_b32 s58, s37, 10
    s_add_u32 s58, s58, 10518528
    s_add_u32 s95, s58, 64
    s_lshl_b32 s49, s38, 4
    s_add_u32 s49, s49, s36
    s_lshl_b32 s49, s49, 3
    s_add_u32 s93, s49, s58
    s_and_b32 s92, s57, 0xffff
    s_add_u32 s92, s92, 98304
    s_lshl_b32 s62, s36, 16
    s_lshl_b32 s45, s100, 7
    s_add_u32 s62, s62, s45
    s_lshl_b32 s63, s36, 13
    s_mov_b32 s12, s68
    s_and_b32 s13, s69, 0xffff
    s_mov_b32 s14, 524288
    s_mov_b32 s15, 0x20000
    v_mov_b32 v21, 0
    v_mov_b32 v22, 0xff800000
    s_mov_b32 s48, 0xffffffff
    s_mov_b32 s49, 0xfffffff0
    v_cndmask_b32 v212, v21, v22, s[48:49]
    s_mov_b32 s50, 0xfffffffe
    s_mov_b32 s51, 0xffffffe0
    v_cndmask_b32 v213, v21, v22, s[50:51]
    s_mov_b32 s48, 0xfffffffc
    s_mov_b32 s49, 0xffffffc0
    v_cndmask_b32 v214, v21, v22, s[48:49]
    s_mov_b32 s50, 0xfffffff8
    s_mov_b32 s51, 0xffffff80
    v_cndmask_b32 v215, v21, v22, s[50:51]
    s_mov_b32 s48, 0xffffff00
    s_mov_b32 s49, 0xfffff000
    v_cndmask_b32 v216, v21, v22, s[48:49]
    s_mov_b32 s50, 0xfffffe00
    s_mov_b32 s51, 0xffffe000
    v_cndmask_b32 v217, v21, v22, s[50:51]
    s_mov_b32 s48, 0xfffffc00
    s_mov_b32 s49, 0xffffc000
    v_cndmask_b32 v218, v21, v22, s[48:49]
    s_mov_b32 s50, 0xfffff800
    s_mov_b32 s51, 0xffff8000
    v_cndmask_b32 v219, v21, v22, s[50:51]
    s_mov_b32 s48, 0xffff0000
    s_mov_b32 s49, 0xfff00000
    v_cndmask_b32 v220, v21, v22, s[48:49]
    s_mov_b32 s50, 0xfffe0000
    s_mov_b32 s51, 0xffe00000
    v_cndmask_b32 v221, v21, v22, s[50:51]
    s_mov_b32 s48, 0xfffc0000
    s_mov_b32 s49, 0xffc00000
    v_cndmask_b32 v222, v21, v22, s[48:49]
    s_mov_b32 s50, 0xfff80000
    s_mov_b32 s51, 0xff800000
    v_cndmask_b32 v223, v21, v22, s[50:51]
    s_mov_b32 s48, 0xff000000
    s_mov_b32 s49, 0xf0000000
    v_cndmask_b32 v224, v21, v22, s[48:49]
    s_mov_b32 s50, 0xfe000000
    s_mov_b32 s51, 0xe0000000
    v_cndmask_b32 v225, v21, v22, s[50:51]
    s_mov_b32 s48, 0xfc000000
    s_mov_b32 s49, 0xc0000000
    v_cndmask_b32 v226, v21, v22, s[48:49]
    s_mov_b32 s50, 0xf8000000
    s_mov_b32 s51, 0x80000000
    v_cndmask_b32 v227, v21, v22, s[50:51]
    s_mov_b32 s48, 0x110000
    s_mov_b32 s49, 0x110000
    v_mov_b32 v229, 0x3f803f80
    v_cndmask_b32 v228, 0, v229, s[48:49]
    v_mov_b32 v229, v228
    v_mov_b64 v[230:231], v[228:229]
    v_mov_b64 v[232:233], v[228:229]
    v_mov_b64 v[234:235], v[228:229]
    v_mov_b64 v[236:237], v[228:229]
    v_mov_b64 v[238:239], v[228:229]
    v_mov_b64 v[240:241], v[228:229]
    v_mov_b64 v[242:243], v[228:229]
    s_lshl_b32 s45, s100, 12
    s_lshl_b32 s48, s53, 10
    s_add_u32 s45, s45, s48
    s_add_u32 s24, s45, 10878976
    v_lshrrev_b32 v200, 3, v1
    v_lshlrev_b32 v200, 12, v200
    v_and_b32 v210, 7, v1
    v_lshl_add_u32 v200, v210, 4, v200
    s_lshl_b32 s25, s100, 18
    s_lshl_b32 s45, s37, 7
    s_add_u32 s25, s25, s45
    s_lshl_b32 s45, s53, 16
    s_add_u32 s25, s25, s45
    s_add_u32 s25, s25, 8388608
    v_and_b32 v11, 7, v1
    v_lshlrev_b32 v11, 3, v11
    v_lshrrev_b32 v10, 3, v1
    v_and_b32 v10, 1, v10
    s_lshl_b32 s45, s53, 1
    v_add_u32 v10, s45, v10
    v_cmp_eq_u32 vcc, s38, v10
    v_xor_b32 v21, 1, v10
    s_cmp_eq_u32 s38, s45
    s_cselect_b64 s[70:71], 0, -1
    v_cndmask_b32 v10, v10, v21, vcc
    v_lshl_add_u32 v10, v10, 7, v11
    s_add_u32 s45, s45, 1
    s_cmp_eq_u32 s38, s45
    s_cselect_b64 s[72:73], 0, -1
    s_and_b32 s76, s70, 0xff
    s_and_b32 s77, s72, 0xff00
    s_lshl_b32 s74, s53, 14
    s_lshl_b32 s75, s37, 16
    s_add_u32 s75, s75, s74
    s_add_u32 s75, s75, 6291456
    s_lshl_b32 s45, s90, 7
    s_add_u32 s45, s45, s19
    s_mul_i32 s48, s90, 196608
    s_add_u32 s48, s48, s20
    s_add_u32 m0, s21, 24576
    s_add_u32 s49, s45, 8192
    buffer_load_dwordx4 v4, s[4:7], s45 offen lds
    s_add_u32 m0, s21, 25600
    s_add_u32 s50, s48, 24576
    buffer_load_dwordx4 v5, s[4:7], s49 offen lds
    s_add_u32 m0, s21, 26624
    s_add_u32 s90, s90, 1
    buffer_load_dwordx4 v6, s[8:11], s48 offen lds
    buffer_load_dwordx4 v6, s[8:11], s48 offen offset:1024 lds
    s_add_u32 m0, s21, 28672
    s_and_b32 s90, s90, 7
    buffer_load_dwordx4 v6, s[8:11], s50 offen lds
    buffer_load_dwordx4 v6, s[8:11], s50 offen offset:1024 lds
    s_waitcnt lgkmcnt(0)
    s_barrier
    s_lshl_b32 s45, s90, 7
    s_add_u32 s45, s45, s19
    s_mul_i32 s48, s90, 196608
    s_add_u32 s48, s48, s20
    s_add_u32 m0, s21, 49152
    s_add_u32 s49, s45, 8192
    buffer_load_dwordx4 v4, s[4:7], s45 offen lds
    s_add_u32 m0, s21, 50176
    s_add_u32 s50, s48, 24576
    buffer_load_dwordx4 v5, s[4:7], s49 offen lds
    s_add_u32 m0, s21, 51200
    s_add_u32 s90, s90, 1
    buffer_load_dwordx4 v6, s[8:11], s48 offen lds
    buffer_load_dwordx4 v6, s[8:11], s48 offen offset:1024 lds
    s_add_u32 m0, s21, 53248
    s_and_b32 s90, s90, 7
    buffer_load_dwordx4 v6, s[8:11], s50 offen lds
    buffer_load_dwordx4 v6, s[8:11], s50 offen offset:1024 lds
    s_waitcnt vmcnt(12)
    s_barrier
    ds_read_b128 v[40:43], v56 offset:0
    ds_read_b128 v[44:47], v57 offset:0
    s_mov_b64 exec, s[26:27]
    ds_read_b128 v[48:51], v60 offset:0
    ds_read_b128 v[52:55], v60 offset:32
    s_mov_b64 exec, -1
    s_lshl_b32 s45, s90, 7
    s_add_u32 s45, s45, s19
    s_mul_i32 s48, s90, 196608
    s_add_u32 s48, s48, s20
    s_add_u32 m0, s21, 73728
    s_add_u32 s49, s45, 8192
    buffer_load_dwordx4 v4, s[4:7], s45 offen lds
    s_add_u32 m0, s21, 74752
    s_add_u32 s50, s48, 24576
    buffer_load_dwordx4 v5, s[4:7], s49 offen lds
    s_add_u32 m0, s21, 75776
    s_add_u32 s90, s90, 1
    buffer_load_dwordx4 v6, s[8:11], s48 offen lds
    buffer_load_dwordx4 v6, s[8:11], s48 offen offset:1024 lds
    s_add_u32 m0, s21, 77824
    s_and_b32 s90, s90, 7
    buffer_load_dwordx4 v6, s[8:11], s50 offen lds
    buffer_load_dwordx4 v6, s[8:11], s50 offen offset:1024 lds
    s_waitcnt lgkmcnt(0)
    v_mfma_f32_32x32x16_bf16 v[24:39], v[48:51], v[40:43], 0
    v_mfma_f32_32x32x16_bf16 v[24:39], v[52:55], v[44:47], v[24:39]
    s_waitcnt vmcnt(12)
    s_barrier
    ds_read_b128 v[40:43], v56 offset:24576
    ds_read_b128 v[44:47], v57 offset:24576
    s_mov_b64 exec, s[26:27]
    ds_read_b128 v[48:51], v60 offset:128
    ds_read_b128 v[52:55], v60 offset:160
    s_mov_b64 exec, -1
    ds_read_b128 v[72:75], v62 offset:0
    ds_read_b32 v76, v62 offset:16
    ds_read_b128 v[80:83], v62 offset:1024
    ds_read_b32 v84, v62 offset:1040
    s_lshl_b32 s45, s90, 7
    s_add_u32 s45, s45, s19
    s_mul_i32 s48, s90, 196608
    s_add_u32 s48, s48, s20
    s_add_u32 m0, s21, 0
    s_add_u32 s49, s45, 8192
    buffer_load_dwordx4 v4, s[4:7], s45 offen lds
    s_add_u32 m0, s21, 1024
    s_add_u32 s50, s48, 24576
    buffer_load_dwordx4 v5, s[4:7], s49 offen lds
    s_add_u32 m0, s21, 2048
    s_add_u32 s90, s90, 1
    buffer_load_dwordx4 v6, s[8:11], s48 offen lds
    buffer_load_dwordx4 v6, s[8:11], s48 offen offset:1024 lds
    s_add_u32 m0, s21, 4096
    s_and_b32 s90, s90, 7
    buffer_load_dwordx4 v6, s[8:11], s50 offen lds
    buffer_load_dwordx4 v6, s[8:11], s50 offen offset:1024 lds
    s_waitcnt lgkmcnt(0)
    v_alignbit_b32 v88, v73, v72, 16
    v_alignbit_b32 v89, v74, v73, 16
    v_alignbit_b32 v90, v75, v74, 16
    v_alignbit_b32 v91, v76, v75, 16
    ds_write_b128 v62, v[88:91] offset:4160
    v_alignbit_b32 v92, v81, v80, 16
    v_alignbit_b32 v93, v82, v81, 16
    v_alignbit_b32 v94, v83, v82, 16
    v_alignbit_b32 v95, v84, v83, 16
    ds_write_b128 v62, v[92:95] offset:5184
    v_mfma_f32_32x32x16_bf16 v[24:39], v[48:51], v[40:43], v[24:39]
    v_mfma_f32_32x32x16_bf16 v[24:39], v[52:55], v[44:47], v[24:39]
    s_waitcnt vmcnt(12)
    s_barrier
    ds_read_b128 v[40:43], v58 offset:0
    ds_read_b128 v[44:47], v59 offset:0
    s_mov_b64 exec, s[26:27]
    ds_read_b128 v[48:51], v60 offset:256
    ds_read_b128 v[52:55], v60 offset:288
    s_mov_b64 exec, -1
    s_lshl_b32 s45, s90, 7
    s_add_u32 s45, s45, s19
    s_mul_i32 s48, s90, 196608
    s_add_u32 s48, s48, s20
    s_add_u32 m0, s21, 24576
    s_add_u32 s49, s45, 8192
    buffer_load_dwordx4 v4, s[4:7], s45 offen lds
    s_add_u32 m0, s21, 25600
    s_add_u32 s50, s48, 24576
    buffer_load_dwordx4 v5, s[4:7], s49 offen lds
    s_add_u32 m0, s21, 26624
    s_add_u32 s90, s90, 1
    buffer_load_dwordx4 v6, s[8:11], s48 offen lds
    buffer_load_dwordx4 v6, s[8:11], s48 offen offset:1024 lds
    s_add_u32 m0, s21, 28672
    s_and_b32 s90, s90, 7
    buffer_load_dwordx4 v6, s[8:11], s50 offen lds
    buffer_load_dwordx4 v6, s[8:11], s50 offen offset:1024 lds
    s_waitcnt lgkmcnt(0)
    v_mfma_f32_32x32x16_bf16 v[24:39], v[48:51], v[40:43], v[24:39]
    v_mfma_f32_32x32x16_bf16 v[24:39], v[52:55], v[44:47], v[24:39]
    s_waitcnt vmcnt(12)
    s_barrier
    ds_read_b128 v[40:43], v58 offset:24576
    ds_read_b128 v[44:47], v59 offset:24576
    s_mov_b64 exec, s[26:27]
    ds_read_b128 v[48:51], v60 offset:384
    ds_read_b128 v[52:55], v60 offset:416
    s_mov_b64 exec, -1
    s_lshl_b32 s45, s52, 4
    s_lshr_b32 s45, s78, s45
    v_mov_b32 v71, s45
    ds_write_b16 v70, v71 offset:32
    s_lshl_b32 s45, s90, 7
    s_add_u32 s45, s45, s19
    s_mul_i32 s48, s90, 196608
    s_add_u32 s48, s48, s20
    s_add_u32 m0, s21, 49152
    s_add_u32 s49, s45, 8192
    buffer_load_dwordx4 v4, s[4:7], s45 offen lds
    s_add_u32 m0, s21, 50176
    s_add_u32 s50, s48, 24576
    buffer_load_dwordx4 v5, s[4:7], s49 offen lds
    s_add_u32 m0, s21, 51200
    s_add_u32 s90, s90, 1
    buffer_load_dwordx4 v6, s[8:11], s48 offen lds
    buffer_load_dwordx4 v6, s[8:11], s48 offen offset:1024 lds
    s_add_u32 m0, s21, 53248
    s_and_b32 s90, s90, 7
    buffer_load_dwordx4 v6, s[8:11], s50 offen lds
    buffer_load_dwordx4 v6, s[8:11], s50 offen offset:1024 lds
    s_waitcnt lgkmcnt(0)
    v_mfma_f32_32x32x16_bf16 v[24:39], v[48:51], v[40:43], v[24:39]
    v_mfma_f32_32x32x16_bf16 v[24:39], v[52:55], v[44:47], v[24:39]
    s_waitcnt vmcnt(12)
    s_barrier
    ds_read_b128 v[40:43], v56 offset:0
    ds_read_b128 v[44:47], v57 offset:0
    s_mov_b64 exec, s[26:27]
    ds_read_b128 v[48:51], v60 offset:512
    ds_read_b128 v[52:55], v60 offset:544
    s_mov_b64 exec, -1
    ds_read_b128 v[204:207], v203
    v_mov_b32 v64, 142848
    ds_read_b64 v[64:65], v64
    buffer_load_dwordx2 v[68:69], v23, s[28:31], s34 offen sc1
    s_lshl_b32 s45, s90, 7
    s_add_u32 s45, s45, s19
    s_mul_i32 s48, s90, 196608
    s_add_u32 s48, s48, s20
    s_add_u32 m0, s21, 73728
    s_add_u32 s49, s45, 8192
    buffer_load_dwordx4 v4, s[4:7], s45 offen lds
    s_add_u32 m0, s21, 74752
    s_add_u32 s50, s48, 24576
    buffer_load_dwordx4 v5, s[4:7], s49 offen lds
    s_add_u32 m0, s21, 75776
    s_add_u32 s90, s90, 1
    buffer_load_dwordx4 v6, s[8:11], s48 offen lds
    buffer_load_dwordx4 v6, s[8:11], s48 offen offset:1024 lds
    s_add_u32 m0, s21, 77824
    s_and_b32 s90, s90, 7
    buffer_load_dwordx4 v6, s[8:11], s50 offen lds
    buffer_load_dwordx4 v6, s[8:11], s50 offen offset:1024 lds
    s_waitcnt lgkmcnt(0)
    v_mfma_f32_32x32x16_bf16 v[24:39], v[48:51], v[40:43], v[24:39]
    v_mfma_f32_32x32x16_bf16 v[24:39], v[52:55], v[44:47], v[24:39]
    s_waitcnt vmcnt(13)
    s_barrier
    ds_read_b128 v[40:43], v56 offset:24576
    ds_read_b128 v[44:47], v57 offset:24576
    s_mov_b64 exec, s[26:27]
    ds_read_b128 v[48:51], v60 offset:640
    ds_read_b128 v[52:55], v60 offset:672
    s_mov_b64 exec, -1
    v_readfirstlane_b32 s42, v64
    v_readfirstlane_b32 s43, v65
    s_waitcnt lgkmcnt(0)
    v_mfma_f32_32x32x16_bf16 v[24:39], v[48:51], v[40:43], v[24:39]
    v_mfma_f32_32x32x16_bf16 v[24:39], v[52:55], v[44:47], v[24:39]
    s_waitcnt vmcnt(7)
    s_barrier
    ds_read_b128 v[40:43], v58 offset:0
    ds_read_b128 v[44:47], v59 offset:0
    s_mov_b64 exec, s[26:27]
    ds_read_b128 v[48:51], v60 offset:768
    ds_read_b128 v[52:55], v60 offset:800
    s_mov_b64 exec, -1
    s_waitcnt vmcnt(6)
    s_mov_b32 s44, 200000
    s_branch POLLC_14
POLL_12:
    buffer_load_dwordx2 v[68:69], v23, s[28:31], s34 offen sc1
    s_waitcnt vmcnt(0)
POLLC_14:
    v_cmp_ne_u64 vcc, s[42:43], v[68:69]
    s_sub_u32 s44, s44, 1
    s_cbranch_scc1 POLLD_13
    s_cbranch_vccnz POLL_12
POLLD_13:
    s_add_u32 s45, s23, 6291456
    s_mov_b32 m0, s32
    s_add_u32 s23, s23, 8388608
    buffer_load_dwordx4 v211, s[28:31], s45 offen sc1 lds
    buffer_load_dwordx4 v211, s[28:31], s45 offen offset:1024 sc1 lds
    s_mul_i32 s48, s90, 196608
    s_add_u32 s48, s48, s20
    s_sub_u32 s48, s48, 1024
    s_add_u32 m0, s22, 0
    s_add_u32 s50, s48, 24576
    buffer_load_dwordx4 v6, s[8:11], s48 offen lds
    s_add_u32 m0, s22, 1024
    s_add_u32 s90, s90, 1
    buffer_load_dwordx4 v6, s[8:11], s50 offen lds
    s_and_b32 s90, s90, 7
    s_waitcnt lgkmcnt(0)
    v_mfma_f32_32x32x16_bf16 v[24:39], v[48:51], v[40:43], v[24:39]
    v_mfma_f32_32x32x16_bf16 v[24:39], v[52:55], v[44:47], v[24:39]
    s_waitcnt vmcnt(4)
    s_barrier
    ds_read_b128 v[40:43], v58 offset:24576
    ds_read_b128 v[44:47], v59 offset:24576
    s_mov_b64 exec, s[26:27]
    ds_read_b128 v[48:51], v60 offset:896
    ds_read_b128 v[52:55], v60 offset:928
    s_mov_b64 exec, -1
    s_waitcnt lgkmcnt(0)
    v_mfma_f32_32x32x16_bf16 v[24:39], v[48:51], v[40:43], v[24:39]
    v_mfma_f32_32x32x16_bf16 v[24:39], v[52:55], v[44:47], v[24:39]
    ds_write_b32 v255, v66
    ds_write_b32 v255, v66 offset:4
    ds_write_b32 v255, v66 offset:8
    s_nop 8
    ds_write_b32 v61, v24
    ds_read2_b32 v[72:73], v16 offset0:0 offset1:1
    ds_read2_b32 v[74:75], v16 offset0:2 offset1:3
    ds_read2_b32 v[76:77], v16 offset0:128 offset1:129
    ds_read2_b32 v[78:79], v16 offset0:130 offset1:131
    ds_read2_b32 v[80:81], v17 offset0:0 offset1:1
    ds_read2_b32 v[82:83], v17 offset0:2 offset1:3
    ds_read2_b32 v[84:85], v17 offset0:128 offset1:129
    ds_read2_b32 v[86:87], v17 offset0:130 offset1:131
    ds_read2_b32 v[88:89], v18 offset0:0 offset1:1
    ds_read2_b32 v[90:91], v18 offset0:2 offset1:3
    ds_read2_b32 v[92:93], v18 offset0:128 offset1:129
    ds_read2_b32 v[94:95], v18 offset0:130 offset1:131
    ds_read2_b32 v[96:97], v19 offset0:0 offset1:1
    ds_read2_b32 v[98:99], v19 offset0:2 offset1:3
    ds_read2_b32 v[100:101], v19 offset0:128 offset1:129
    ds_read2_b32 v[102:103], v19 offset0:130 offset1:131
    s_waitcnt vmcnt(2) lgkmcnt(0)
    s_barrier
    ds_read_b128 v[104:107], v201 offset:3584
    ds_read_b128 v[108:111], v201 offset:3072
    ds_read_b128 v[112:115], v201 offset:2560
    ds_read_b128 v[116:119], v201 offset:2048
    ds_read_b128 v[120:123], v201 offset:1536
    ds_read_b128 v[124:127], v201 offset:1024
    ds_read_b128 v[128:131], v201 offset:512
    ds_read_b128 v[132:135], v201 offset:0
    s_waitcnt lgkmcnt(7)
    v_mfma_f32_16x16x32_bf16 v[24:27], v[72:75], v[104:107], 0
    s_waitcnt lgkmcnt(6)
    v_mfma_f32_16x16x32_bf16 v[28:31], v[72:75], v[108:111], 0
    v_mfma_f32_16x16x32_bf16 v[28:31], v[76:79], v[104:107], v[28:31]
    v_mfma_f32_16x16x32_bf16 v[32:35], v[76:79], v[108:111], 0
    s_waitcnt lgkmcnt(5)
    v_mfma_f32_16x16x32_bf16 v[32:35], v[72:75], v[112:115], v[32:35]
    v_mfma_f32_16x16x32_bf16 v[32:35], v[80:83], v[104:107], v[32:35]
    v_mfma_f32_16x16x32_bf16 v[36:39], v[76:79], v[112:115], 0
    v_mfma_f32_16x16x32_bf16 v[36:39], v[80:83], v[108:111], v[36:39]
    v_mfma_f32_16x16x32_bf16 v[40:43], v[80:83], v[112:115], 0
    s_waitcnt lgkmcnt(0)
    v_mfma_f32_16x16x32_bf16 v[36:39], v[72:75], v[116:119], v[36:39]
    ds_read_b128 v[168:171], v201 offset:3648
    v_mfma_f32_16x16x32_bf16 v[36:39], v[84:87], v[104:107], v[36:39]
    ds_read2_b32 v[136:137], v16 offset0:16 offset1:17
    v_mfma_f32_16x16x32_bf16 v[40:43], v[76:79], v[116:119], v[40:43]
    ds_read2_b32 v[138:139], v16 offset0:18 offset1:19
    v_mfma_f32_16x16x32_bf16 v[40:43], v[84:87], v[108:111], v[40:43]
    ds_read_b128 v[172:175], v201 offset:3136
    v_mfma_f32_16x16x32_bf16 v[44:47], v[80:83], v[116:119], 0
    ds_read2_b32 v[140:141], v16 offset0:144 offset1:145
    v_mfma_f32_16x16x32_bf16 v[44:47], v[84:87], v[112:115], v[44:47]
    ds_read2_b32 v[142:143], v16 offset0:146 offset1:147
    v_mfma_f32_16x16x32_bf16 v[48:51], v[84:87], v[116:119], 0
    ds_read_b128 v[176:179], v201 offset:2624
    v_mfma_f32_16x16x32_bf16 v[40:43], v[72:75], v[120:123], v[40:43]
    ds_read2_b32 v[144:145], v17 offset0:16 offset1:17
    v_mfma_f32_16x16x32_bf16 v[40:43], v[88:91], v[104:107], v[40:43]
    ds_read2_b32 v[146:147], v17 offset0:18 offset1:19
    v_mfma_f32_16x16x32_bf16 v[44:47], v[76:79], v[120:123], v[44:47]
    ds_read_b128 v[180:183], v201 offset:2112
    v_mfma_f32_16x16x32_bf16 v[44:47], v[88:91], v[108:111], v[44:47]
    ds_read2_b32 v[148:149], v17 offset0:144 offset1:145
    v_mfma_f32_16x16x32_bf16 v[48:51], v[80:83], v[120:123], v[48:51]
    ds_read2_b32 v[150:151], v17 offset0:146 offset1:147
    v_mfma_f32_16x16x32_bf16 v[48:51], v[88:91], v[112:115], v[48:51]
    ds_read_b128 v[184:187], v201 offset:1600
    v_mfma_f32_16x16x32_bf16 v[52:55], v[84:87], v[120:123], 0
    ds_read2_b32 v[152:153], v18 offset0:16 offset1:17
    v_mfma_f32_16x16x32_bf16 v[52:55], v[88:91], v[116:119], v[52:55]
    ds_read2_b32 v[154:155], v18 offset0:18 offset1:19
    v_mfma_f32_16x16x32_bf16 v[44:47], v[72:75], v[124:127], v[44:47]
    ds_read_b128 v[188:191], v201 offset:1088
    v_mfma_f32_16x16x32_bf16 v[44:47], v[92:95], v[104:107], v[44:47]
    ds_read2_b32 v[156:157], v18 offset0:144 offset1:145
    v_mfma_f32_16x16x32_bf16 v[48:51], v[76:79], v[124:127], v[48:51]
    ds_read2_b32 v[158:159], v18 offset0:146 offset1:147
    v_mfma_f32_16x16x32_bf16 v[48:51], v[92:95], v[108:111], v[48:51]
    ds_read_b128 v[192:195], v201 offset:576
    v_mfma_f32_16x16x32_bf16 v[52:55], v[80:83], v[124:127], v[52:55]
    ds_read2_b32 v[160:161], v19 offset0:16 offset1:17
    v_mfma_f32_16x16x32_bf16 v[52:55], v[92:95], v[112:115], v[52:55]
    ds_read2_b32 v[162:163], v19 offset0:18 offset1:19
    v_mfma_f32_16x16x32_bf16 v[48:51], v[72:75], v[128:131], v[48:51]
    ds_read_b128 v[196:199], v201 offset:64
    v_mfma_f32_16x16x32_bf16 v[48:51], v[96:99], v[104:107], v[48:51]
    ds_read2_b32 v[164:165], v19 offset0:144 offset1:145
    v_mfma_f32_16x16x32_bf16 v[52:55], v[76:79], v[128:131], v[52:55]
    ds_read2_b32 v[166:167], v19 offset0:146 offset1:147
    v_mfma_f32_16x16x32_bf16 v[52:55], v[96:99], v[108:111], v[52:55]
    v_mfma_f32_16x16x32_bf16 v[52:55], v[72:75], v[132:135], v[52:55]
    v_mfma_f32_16x16x32_bf16 v[52:55], v[100:103], v[104:107], v[52:55]
    s_waitcnt lgkmcnt(0)
    v_mfma_f32_16x16x32_bf16 v[24:27], v[136:139], v[168:171], v[24:27]
    ds_read_b128 v[104:107], v201 offset:3712
    v_mfma_f32_16x16x32_bf16 v[28:31], v[136:139], v[172:175], v[28:31]
    ds_read2_b32 v[72:73], v16 offset0:32 offset1:33
    v_mfma_f32_16x16x32_bf16 v[28:31], v[140:143], v[168:171], v[28:31]
    ds_read2_b32 v[74:75], v16 offset0:34 offset1:35
    v_mfma_f32_16x16x32_bf16 v[32:35], v[140:143], v[172:175], v[32:35]
    ds_read_b128 v[108:111], v201 offset:3200
    v_mfma_f32_16x16x32_bf16 v[32:35], v[136:139], v[176:179], v[32:35]
    ds_read2_b32 v[76:77], v16 offset0:160 offset1:161
    v_mfma_f32_16x16x32_bf16 v[32:35], v[144:147], v[168:171], v[32:35]
    ds_read2_b32 v[78:79], v16 offset0:162 offset1:163
    v_mfma_f32_16x16x32_bf16 v[36:39], v[140:143], v[176:179], v[36:39]
    ds_read_b128 v[112:115], v201 offset:2688
    v_mfma_f32_16x16x32_bf16 v[36:39], v[144:147], v[172:175], v[36:39]
    ds_read2_b32 v[80:81], v17 offset0:32 offset1:33
    v_mfma_f32_16x16x32_bf16 v[40:43], v[144:147], v[176:179], v[40:43]
    ds_read2_b32 v[82:83], v17 offset0:34 offset1:35
    v_mfma_f32_16x16x32_bf16 v[36:39], v[136:139], v[180:183], v[36:39]
    ds_read_b128 v[116:119], v201 offset:2176
    v_mfma_f32_16x16x32_bf16 v[36:39], v[148:151], v[168:171], v[36:39]
    ds_read2_b32 v[84:85], v17 offset0:160 offset1:161
    v_mfma_f32_16x16x32_bf16 v[40:43], v[140:143], v[180:183], v[40:43]
    ds_read2_b32 v[86:87], v17 offset0:162 offset1:163
    v_mfma_f32_16x16x32_bf16 v[40:43], v[148:151], v[172:175], v[40:43]
    ds_read_b128 v[120:123], v201 offset:1664
    v_mfma_f32_16x16x32_bf16 v[44:47], v[144:147], v[180:183], v[44:47]
    ds_read2_b32 v[88:89], v18 offset0:32 offset1:33
    v_mfma_f32_16x16x32_bf16 v[44:47], v[148:151], v[176:179], v[44:47]
    ds_read2_b32 v[90:91], v18 offset0:34 offset1:35
    v_mfma_f32_16x16x32_bf16 v[48:51], v[148:151], v[180:183], v[48:51]
    ds_read_b128 v[124:127], v201 offset:1152
    v_mfma_f32_16x16x32_bf16 v[40:43], v[136:139], v[184:187], v[40:43]
    ds_read2_b32 v[92:93], v18 offset0:160 offset1:161
    v_mfma_f32_16x16x32_bf16 v[40:43], v[152:155], v[168:171], v[40:43]
    ds_read2_b32 v[94:95], v18 offset0:162 offset1:163
    v_mfma_f32_16x16x32_bf16 v[44:47], v[140:143], v[184:187], v[44:47]
    ds_read_b128 v[128:131], v201 offset:640
    v_mfma_f32_16x16x32_bf16 v[44:47], v[152:155], v[172:175], v[44:47]
    ds_read2_b32 v[96:97], v19 offset0:32 offset1:33
    v_mfma_f32_16x16x32_bf16 v[48:51], v[144:147], v[184:187], v[48:51]
    ds_read2_b32 v[98:99], v19 offset0:34 offset1:35
    v_mfma_f32_16x16x32_bf16 v[48:51], v[152:155], v[176:179], v[48:51]
    ds_read_b128 v[132:135], v201 offset:128
    v_mfma_f32_16x16x32_bf16 v[52:55], v[148:151], v[184:187], v[52:55]
    ds_read2_b32 v[100:101], v19 offset0:160 offset1:161
    v_mfma_f32_16x16x32_bf16 v[52:55], v[152:155], v[180:183], v[52:55]
    ds_read2_b32 v[102:103], v19 offset0:162 offset1:163
    v_mfma_f32_16x16x32_bf16 v[44:47], v[136:139], v[188:191], v[44:47]
    v_mfma_f32_16x16x32_bf16 v[44:47], v[156:159], v[168:171], v[44:47]
    v_mfma_f32_16x16x32_bf16 v[48:51], v[140:143], v[188:191], v[48:51]
    v_mfma_f32_16x16x32_bf16 v[48:51], v[156:159], v[172:175], v[48:51]
    v_mfma_f32_16x16x32_bf16 v[52:55], v[144:147], v[188:191], v[52:55]
    v_mfma_f32_16x16x32_bf16 v[52:55], v[156:159], v[176:179], v[52:55]
    v_mfma_f32_16x16x32_bf16 v[48:51], v[136:139], v[192:195], v[48:51]
    v_mfma_f32_16x16x32_bf16 v[48:51], v[160:163], v[168:171], v[48:51]
    v_mfma_f32_16x16x32_bf16 v[52:55], v[140:143], v[192:195], v[52:55]
    v_mfma_f32_16x16x32_bf16 v[52:55], v[160:163], v[172:175], v[52:55]
    v_mfma_f32_16x16x32_bf16 v[52:55], v[136:139], v[196:199], v[52:55]
    v_mfma_f32_16x16x32_bf16 v[52:55], v[164:167], v[168:171], v[52:55]
    s_waitcnt lgkmcnt(0)
    v_mfma_f32_16x16x32_bf16 v[24:27], v[72:75], v[104:107], v[24:27]
    ds_read_b128 v[168:171], v201 offset:3776
    v_mfma_f32_16x16x32_bf16 v[28:31], v[72:75], v[108:111], v[28:31]
    ds_read2_b32 v[136:137], v16 offset0:48 offset1:49
    v_mfma_f32_16x16x32_bf16 v[28:31], v[76:79], v[104:107], v[28:31]
    ds_read2_b32 v[138:139], v16 offset0:50 offset1:51
    v_mfma_f32_16x16x32_bf16 v[32:35], v[76:79], v[108:111], v[32:35]
    ds_read_b128 v[172:175], v201 offset:3264
    v_mfma_f32_16x16x32_bf16 v[32:35], v[72:75], v[112:115], v[32:35]
    ds_read2_b32 v[140:141], v16 offset0:176 offset1:177
    v_mfma_f32_16x16x32_bf16 v[32:35], v[80:83], v[104:107], v[32:35]
    ds_read2_b32 v[142:143], v16 offset0:178 offset1:179
    v_mfma_f32_16x16x32_bf16 v[36:39], v[76:79], v[112:115], v[36:39]
    ds_read_b128 v[176:179], v201 offset:2752
    v_mfma_f32_16x16x32_bf16 v[36:39], v[80:83], v[108:111], v[36:39]
    ds_read2_b32 v[144:145], v17 offset0:48 offset1:49
    v_mfma_f32_16x16x32_bf16 v[40:43], v[80:83], v[112:115], v[40:43]
    ds_read2_b32 v[146:147], v17 offset0:50 offset1:51
    v_mfma_f32_16x16x32_bf16 v[36:39], v[72:75], v[116:119], v[36:39]
    ds_read_b128 v[180:183], v201 offset:2240
    v_mfma_f32_16x16x32_bf16 v[36:39], v[84:87], v[104:107], v[36:39]
    ds_read2_b32 v[148:149], v17 offset0:176 offset1:177
    v_mfma_f32_16x16x32_bf16 v[40:43], v[76:79], v[116:119], v[40:43]
    ds_read2_b32 v[150:151], v17 offset0:178 offset1:179
    v_mfma_f32_16x16x32_bf16 v[40:43], v[84:87], v[108:111], v[40:43]
    ds_read_b128 v[184:187], v201 offset:1728
    v_mfma_f32_16x16x32_bf16 v[44:47], v[80:83], v[116:119], v[44:47]
    ds_read2_b32 v[152:153], v18 offset0:48 offset1:49
    v_mfma_f32_16x16x32_bf16 v[44:47], v[84:87], v[112:115], v[44:47]
    ds_read2_b32 v[154:155], v18 offset0:50 offset1:51
    v_mfma_f32_16x16x32_bf16 v[48:51], v[84:87], v[116:119], v[48:51]
    ds_read_b128 v[188:191], v201 offset:1216
    v_mfma_f32_16x16x32_bf16 v[40:43], v[72:75], v[120:123], v[40:43]
    ds_read2_b32 v[156:157], v18 offset0:176 offset1:177
    v_mfma_f32_16x16x32_bf16 v[40:43], v[88:91], v[104:107], v[40:43]
    ds_read2_b32 v[158:159], v18 offset0:178 offset1:179
    s_waitcnt vmcnt(0)
    s_barrier
    v_mfma_f32_16x16x32_bf16 v[44:47], v[76:79], v[120:123], v[44:47]
    ds_read_b128 v[192:195], v201 offset:704
    v_mfma_f32_16x16x32_bf16 v[44:47], v[88:91], v[108:111], v[44:47]
    ds_read2_b32 v[160:161], v19 offset0:48 offset1:49
    v_mfma_f32_16x16x32_bf16 v[48:51], v[80:83], v[120:123], v[48:51]
    ds_read2_b32 v[162:163], v19 offset0:50 offset1:51
    v_mfma_f32_16x16x32_bf16 v[48:51], v[88:91], v[112:115], v[48:51]
    ds_read_b128 v[196:199], v201 offset:192
    v_mfma_f32_16x16x32_bf16 v[52:55], v[84:87], v[120:123], v[52:55]
    ds_read2_b32 v[164:165], v19 offset0:176 offset1:177
    v_mfma_f32_16x16x32_bf16 v[52:55], v[88:91], v[116:119], v[52:55]
    ds_read2_b32 v[166:167], v19 offset0:178 offset1:179
    v_mfma_f32_16x16x32_bf16 v[44:47], v[72:75], v[124:127], v[44:47]
    ds_read_b128 v[56:59], v202 offset:1536
    v_mfma_f32_16x16x32_bf16 v[44:47], v[92:95], v[104:107], v[44:47]
    ds_read_b128 v[60:63], v202 offset:1024
    v_mfma_f32_16x16x32_bf16 v[48:51], v[76:79], v[124:127], v[48:51]
    ds_read_b128 v[64:67], v202 offset:512
    v_mfma_f32_16x16x32_bf16 v[48:51], v[92:95], v[108:111], v[48:51]
    ds_read_b128 v[68:71], v202 offset:0
    buffer_load_dwordx2 v[4:5], v7, s[28:31], s56 offen sc1
    v_mfma_f32_16x16x32_bf16 v[52:55], v[80:83], v[124:127], v[52:55]
    v_mfma_f32_16x16x32_bf16 v[52:55], v[92:95], v[112:115], v[52:55]
    v_mfma_f32_16x16x32_bf16 v[48:51], v[72:75], v[128:131], v[48:51]
    v_mfma_f32_16x16x32_bf16 v[48:51], v[96:99], v[104:107], v[48:51]
    v_mfma_f32_16x16x32_bf16 v[52:55], v[76:79], v[128:131], v[52:55]
    v_mfma_f32_16x16x32_bf16 v[52:55], v[96:99], v[108:111], v[52:55]
    v_mfma_f32_16x16x32_bf16 v[52:55], v[72:75], v[132:135], v[52:55]
    v_mfma_f32_16x16x32_bf16 v[52:55], v[100:103], v[104:107], v[52:55]
    s_waitcnt lgkmcnt(0)
    v_mov_b64 v[76:77], v[228:229]
    v_mov_b64 v[78:79], v[228:229]
    v_mov_b64 v[80:81], v[228:229]
    v_mov_b64 v[82:83], v[228:229]
    v_mov_b64 v[88:89], v[228:229]
    v_mov_b64 v[90:91], v[228:229]
    v_mov_b64 v[92:93], v[228:229]
    v_mov_b64 v[94:95], v[228:229]
    s_barrier
    s_waitcnt vmcnt(0)
    s_cmp_eq_u32 s37, 0
    s_cbranch_scc1 L_LF1OK
    s_mov_b32 s44, 200000
    s_branch POLLC_17
POLL_15:
    buffer_load_dwordx2 v[4:5], v7, s[28:31], s56 offen sc1
    s_waitcnt vmcnt(0)
POLLC_17:
    v_cmp_ne_u64 vcc, s[42:43], v[4:5]
    s_sub_u32 s44, s44, 1
    s_cbranch_scc1 POLLD_16
    s_cbranch_vccnz POLL_15
POLLD_16:
L_LF1OK:
    s_sub_u32 s45, s94, 40960
    s_max_u32 s45, s45, s3
    buffer_load_dwordx4 v[244:247], v211, s[28:31], s45 offen sc1
    s_sub_u32 s45, s94, 40960
    s_max_u32 s45, s45, s3
    s_mov_b64 exec, s[60:61]
    buffer_load_dwordx4 v[228:231], v253, s[28:31], s45 offen sc1
    buffer_load_dwordx4 v[232:235], v253, s[28:31], s45 offen offset:512 sc1
    s_mov_b64 exec, -1
    s_sub_u32 s45, s94, 49152
    s_max_u32 s45, s45, s3
    buffer_load_dwordx4 v[248:251], v211, s[28:31], s45 offen sc1
    s_sub_u32 s45, s94, 49152
    s_max_u32 s45, s45, s3
    s_mov_b64 exec, s[60:61]
    buffer_load_dwordx4 v[236:239], v253, s[28:31], s45 offen sc1
    buffer_load_dwordx4 v[240:243], v253, s[28:31], s45 offen offset:512 sc1
    s_mov_b64 exec, -1
    s_sub_u32 s45, s94, 57344
    s_max_u32 s45, s45, s3
    buffer_load_dwordx4 v[72:75], v211, s[28:31], s45 offen sc1
    s_sub_u32 s45, s94, 57344
    s_max_u32 s45, s45, s3
    s_mov_b64 exec, s[60:61]
    buffer_load_dwordx4 v[76:79], v253, s[28:31], s45 offen sc1
    buffer_load_dwordx4 v[80:83], v253, s[28:31], s45 offen offset:512 sc1
    s_mov_b64 exec, -1
    s_sub_u32 s45, s94, 65536
    s_max_u32 s45, s45, s3
    buffer_load_dwordx4 v[84:87], v211, s[28:31], s45 offen sc1
    s_sub_u32 s45, s94, 65536
    s_max_u32 s45, s45, s3
    s_mov_b64 exec, s[60:61]
    buffer_load_dwordx4 v[88:91], v253, s[28:31], s45 offen sc1
    buffer_load_dwordx4 v[92:95], v253, s[28:31], s45 offen offset:512 sc1
    s_mov_b64 exec, -1
    v_mov_b32 v16, 1
    s_cmp_eq_u32 s17, 0
    s_cbranch_scc0 L_KH1
    v_mfma_f32_16x16x32_bf16 v[40:43], v[136:139], v[184:187], v[40:43]
    v_mfma_f32_16x16x32_bf16 v[40:43], v[140:143], v[180:183], v[40:43]
    v_mfma_f32_16x16x32_bf16 v[40:43], v[144:147], v[176:179], v[40:43]
    v_mfma_f32_16x16x32_bf16 v[40:43], v[148:151], v[172:175], v[40:43]
    v_mfma_f32_16x16x32_bf16 v[40:43], v[152:155], v[168:171], v[40:43]
    s_barrier
    v_mfma_f32_16x16x32_bf16 v[44:47], v[136:139], v[188:191], v[44:47]
    v_mfma_f32_16x16x32_bf16 v[44:47], v[140:143], v[184:187], v[44:47]
    v_mfma_f32_16x16x32_bf16 v[44:47], v[144:147], v[180:183], v[44:47]
    v_mfma_f32_16x16x32_bf16 v[44:47], v[148:151], v[176:179], v[44:47]
    v_mfma_f32_16x16x32_bf16 v[44:47], v[152:155], v[172:175], v[44:47]
    v_mfma_f32_16x16x32_bf16 v[44:47], v[156:159], v[168:171], v[44:47]
    v_mfma_f32_16x16x32_bf16 v[48:51], v[136:139], v[192:195], v[48:51]
    v_mfma_f32_16x16x32_bf16 v[48:51], v[140:143], v[188:191], v[48:51]
    ds_write_b128 v13, v[40:43] offset:0
    v_mfma_f32_16x16x32_bf16 v[48:51], v[144:147], v[184:187], v[48:51]
    v_mfma_f32_16x16x32_bf16 v[48:51], v[148:151], v[180:183], v[48:51]
    v_mfma_f32_16x16x32_bf16 v[48:51], v[152:155], v[176:179], v[48:51]
    v_mfma_f32_16x16x32_bf16 v[48:51], v[156:159], v[172:175], v[48:51]
    v_mfma_f32_16x16x32_bf16 v[48:51], v[160:163], v[168:171], v[48:51]
    v_mfma_f32_16x16x32_bf16 v[52:55], v[136:139], v[196:199], v[52:55]
    ds_write_b128 v13, v[44:47] offset:1024
    v_mfma_f32_16x16x32_bf16 v[52:55], v[140:143], v[192:195], v[52:55]
    v_mfma_f32_16x16x32_bf16 v[52:55], v[144:147], v[188:191], v[52:55]
    v_mfma_f32_16x16x32_bf16 v[52:55], v[148:151], v[184:187], v[52:55]
    v_mfma_f32_16x16x32_bf16 v[52:55], v[152:155], v[180:183], v[52:55]
    v_mfma_f32_16x16x32_bf16 v[52:55], v[156:159], v[176:179], v[52:55]
    v_mfma_f32_16x16x32_bf16 v[52:55], v[160:163], v[172:175], v[52:55]
    v_mfma_f32_16x16x32_bf16 v[52:55], v[164:167], v[168:171], v[52:55]
    ds_write_b128 v13, v[48:51] offset:2048
    v_mfma_f32_16x16x32_bf16 v[24:27], v[136:139], v[168:171], v[24:27]
    v_mfma_f32_16x16x32_bf16 v[28:31], v[136:139], v[172:175], v[28:31]
    v_mfma_f32_16x16x32_bf16 v[28:31], v[140:143], v[168:171], v[28:31]
    v_mfma_f32_16x16x32_bf16 v[32:35], v[136:139], v[176:179], v[32:35]
    v_mfma_f32_16x16x32_bf16 v[32:35], v[140:143], v[172:175], v[32:35]
    v_mfma_f32_16x16x32_bf16 v[32:35], v[144:147], v[168:171], v[32:35]
    v_mfma_f32_16x16x32_bf16 v[36:39], v[136:139], v[180:183], v[36:39]
    v_mfma_f32_16x16x32_bf16 v[36:39], v[140:143], v[176:179], v[36:39]
    ds_write_b128 v13, v[52:55] offset:3072
    v_mfma_f32_16x16x32_bf16 v[36:39], v[144:147], v[172:175], v[36:39]
    v_mfma_f32_16x16x32_bf16 v[36:39], v[148:151], v[168:171], v[36:39]
    v_mfma_f32_16x16x32_bf16 v[24:27], v[204:207], v[56:59], v[24:27]
    v_mfma_f32_16x16x32_bf16 v[28:31], v[204:207], v[60:63], v[28:31]
    v_mfma_f32_16x16x32_bf16 v[32:35], v[204:207], v[64:67], v[32:35]
    v_mfma_f32_16x16x32_bf16 v[36:39], v[204:207], v[68:71], v[36:39]
    s_waitcnt lgkmcnt(0)
    s_mov_b64 exec, 15
    ds_add_u32 v15, v16
    s_mov_b64 exec, -1
    s_setprio 1
    s_mov_b32 s44, 200000
    s_branch LW_18c
LW_18:
    s_sleep 0
LW_18c:
    ds_read_b32 v17, v255
    s_waitcnt lgkmcnt(0)
    v_readfirstlane_b32 s45, v17
    s_sub_u32 s44, s44, 1
    s_cbranch_scc1 LWD_19
    s_cmp_lt_u32 s45, 4
    s_cbranch_scc1 LW_18
LWD_19:
    ds_read_b128 v[144:147], v12 offset:0
    ds_read_b128 v[148:151], v12 offset:1024
    ds_read_b128 v[152:155], v12 offset:2048
    ds_read_b128 v[156:159], v12 offset:3072
    s_waitcnt lgkmcnt(3)
    v_pk_add_f32 v[24:25], v[24:25], v[144:145]
    v_pk_add_f32 v[26:27], v[26:27], v[146:147]
    v_cvt_pk_bf16_f32 v160, v24, v25
    v_cvt_pk_bf16_f32 v161, v26, v27
    s_waitcnt lgkmcnt(2)
    v_pk_add_f32 v[28:29], v[28:29], v[148:149]
    v_pk_add_f32 v[30:31], v[30:31], v[150:151]
    v_cvt_pk_bf16_f32 v162, v28, v29
    v_cvt_pk_bf16_f32 v163, v30, v31
    s_waitcnt lgkmcnt(1)
    v_pk_add_f32 v[32:33], v[32:33], v[152:153]
    v_pk_add_f32 v[34:35], v[34:35], v[154:155]
    v_cvt_pk_bf16_f32 v164, v32, v33
    v_cvt_pk_bf16_f32 v165, v34, v35
    s_waitcnt lgkmcnt(0)
    v_pk_add_f32 v[36:37], v[36:37], v[156:157]
    v_pk_add_f32 v[38:39], v[38:39], v[158:159]
    v_cvt_pk_bf16_f32 v166, v36, v37
    v_cvt_pk_bf16_f32 v167, v38, v39
    s_branch L_KHD
L_KH1:
    v_mfma_f32_16x16x32_bf16 v[24:27], v[136:139], v[168:171], v[24:27]
    v_mfma_f32_16x16x32_bf16 v[28:31], v[136:139], v[172:175], v[28:31]
    v_mfma_f32_16x16x32_bf16 v[28:31], v[140:143], v[168:171], v[28:31]
    v_mfma_f32_16x16x32_bf16 v[32:35], v[136:139], v[176:179], v[32:35]
    v_mfma_f32_16x16x32_bf16 v[32:35], v[140:143], v[172:175], v[32:35]
    s_barrier
    v_mfma_f32_16x16x32_bf16 v[32:35], v[144:147], v[168:171], v[32:35]
    v_mfma_f32_16x16x32_bf16 v[36:39], v[136:139], v[180:183], v[36:39]
    v_mfma_f32_16x16x32_bf16 v[36:39], v[140:143], v[176:179], v[36:39]
    v_mfma_f32_16x16x32_bf16 v[36:39], v[144:147], v[172:175], v[36:39]
    ds_write_b128 v13, v[24:27] offset:0
    v_mfma_f32_16x16x32_bf16 v[36:39], v[148:151], v[168:171], v[36:39]
    v_mfma_f32_16x16x32_bf16 v[40:43], v[136:139], v[184:187], v[40:43]
    ds_write_b128 v13, v[28:31] offset:1024
    v_mfma_f32_16x16x32_bf16 v[40:43], v[140:143], v[180:183], v[40:43]
    v_mfma_f32_16x16x32_bf16 v[40:43], v[144:147], v[176:179], v[40:43]
    v_mfma_f32_16x16x32_bf16 v[40:43], v[148:151], v[172:175], v[40:43]
    ds_write_b128 v13, v[32:35] offset:2048
    v_mfma_f32_16x16x32_bf16 v[40:43], v[152:155], v[168:171], v[40:43]
    v_mfma_f32_16x16x32_bf16 v[44:47], v[136:139], v[188:191], v[44:47]
    v_mfma_f32_16x16x32_bf16 v[44:47], v[140:143], v[184:187], v[44:47]
    v_mfma_f32_16x16x32_bf16 v[44:47], v[144:147], v[180:183], v[44:47]
    ds_write_b128 v13, v[36:39] offset:3072
    v_mfma_f32_16x16x32_bf16 v[44:47], v[148:151], v[176:179], v[44:47]
    v_mfma_f32_16x16x32_bf16 v[44:47], v[152:155], v[172:175], v[44:47]
    v_mfma_f32_16x16x32_bf16 v[44:47], v[156:159], v[168:171], v[44:47]
    v_mfma_f32_16x16x32_bf16 v[48:51], v[136:139], v[192:195], v[48:51]
    v_mfma_f32_16x16x32_bf16 v[48:51], v[140:143], v[188:191], v[48:51]
    v_mfma_f32_16x16x32_bf16 v[48:51], v[144:147], v[184:187], v[48:51]
    v_mfma_f32_16x16x32_bf16 v[48:51], v[148:151], v[180:183], v[48:51]
    v_mfma_f32_16x16x32_bf16 v[48:51], v[152:155], v[176:179], v[48:51]
    v_mfma_f32_16x16x32_bf16 v[48:51], v[156:159], v[172:175], v[48:51]
    v_mfma_f32_16x16x32_bf16 v[48:51], v[160:163], v[168:171], v[48:51]
    v_mfma_f32_16x16x32_bf16 v[52:55], v[136:139], v[196:199], v[52:55]
    v_mfma_f32_16x16x32_bf16 v[52:55], v[140:143], v[192:195], v[52:55]
    v_mfma_f32_16x16x32_bf16 v[52:55], v[144:147], v[188:191], v[52:55]
    v_mfma_f32_16x16x32_bf16 v[52:55], v[148:151], v[184:187], v[52:55]
    v_mfma_f32_16x16x32_bf16 v[52:55], v[152:155], v[180:183], v[52:55]
    v_mfma_f32_16x16x32_bf16 v[52:55], v[156:159], v[176:179], v[52:55]
    v_mfma_f32_16x16x32_bf16 v[52:55], v[160:163], v[172:175], v[52:55]
    v_mfma_f32_16x16x32_bf16 v[52:55], v[164:167], v[168:171], v[52:55]
    v_mfma_f32_16x16x32_bf16 v[40:43], v[204:207], v[56:59], v[40:43]
    v_mfma_f32_16x16x32_bf16 v[44:47], v[204:207], v[60:63], v[44:47]
    v_mfma_f32_16x16x32_bf16 v[48:51], v[204:207], v[64:67], v[48:51]
    v_mfma_f32_16x16x32_bf16 v[52:55], v[204:207], v[68:71], v[52:55]
    s_waitcnt lgkmcnt(0)
    s_mov_b64 exec, 15
    ds_add_u32 v15, v16
    s_mov_b64 exec, -1
    s_setprio 1
    s_mov_b32 s44, 200000
    s_branch LW_20c
LW_20:
    s_sleep 0
LW_20c:
    ds_read_b32 v17, v255
    s_waitcnt lgkmcnt(0)
    v_readfirstlane_b32 s45, v17
    s_sub_u32 s44, s44, 1
    s_cbranch_scc1 LWD_21
    s_cmp_lt_u32 s45, 4
    s_cbranch_scc1 LW_20
LWD_21:
    ds_read_b128 v[144:147], v12 offset:0
    ds_read_b128 v[148:151], v12 offset:1024
    ds_read_b128 v[152:155], v12 offset:2048
    ds_read_b128 v[156:159], v12 offset:3072
    s_waitcnt lgkmcnt(3)
    v_pk_add_f32 v[40:41], v[40:41], v[144:145]
    v_pk_add_f32 v[42:43], v[42:43], v[146:147]
    v_cvt_pk_bf16_f32 v160, v40, v41
    v_cvt_pk_bf16_f32 v161, v42, v43
    s_waitcnt lgkmcnt(2)
    v_pk_add_f32 v[44:45], v[44:45], v[148:149]
    v_pk_add_f32 v[46:47], v[46:47], v[150:151]
    v_cvt_pk_bf16_f32 v162, v44, v45
    v_cvt_pk_bf16_f32 v163, v46, v47
    s_waitcnt lgkmcnt(1)
    v_pk_add_f32 v[48:49], v[48:49], v[152:153]
    v_pk_add_f32 v[50:51], v[50:51], v[154:155]
    v_cvt_pk_bf16_f32 v164, v48, v49
    v_cvt_pk_bf16_f32 v165, v50, v51
    s_waitcnt lgkmcnt(0)
    v_pk_add_f32 v[52:53], v[52:53], v[156:157]
    v_pk_add_f32 v[54:55], v[54:55], v[158:159]
    v_cvt_pk_bf16_f32 v166, v52, v53
    v_cvt_pk_bf16_f32 v167, v54, v55
L_KHD:
    s_mov_b64 exec, 15
    ds_add_u32 v15, v16
    s_mov_b64 exec, -1
    buffer_store_dwordx2 v[160:161], v208, s[28:31], s23 offen offset:0 sc1
    buffer_store_dwordx2 v[162:163], v208, s[28:31], s23 offen offset:512 sc1
    buffer_store_dwordx2 v[164:165], v208, s[28:31], s23 offen offset:1024 sc1
    buffer_store_dwordx2 v[166:167], v208, s[28:31], s23 offen offset:1536 sc1
    ds_read_b128 v[120:123], v14
    ds_read_b128 v[124:127], v14 offset:4096
    s_waitcnt lgkmcnt(0)
    s_waitcnt vmcnt(13)
    s_cmp_le_u32 s55, 3
    s_cbranch_scc1 KV_22
    v_mov_b64 v[228:229], 0
    v_mov_b64 v[230:231], 0
    v_mov_b64 v[232:233], 0
    v_mov_b64 v[234:235], 0
    s_nop 1
KV_22:
    v_mfma_f32_32x32x16_bf16 v[16:31], v[244:247], v[120:123], 0
    s_nop 11
    v_exp_f32 v16, v16
    v_exp_f32 v17, v17
    v_exp_f32 v18, v18
    v_exp_f32 v19, v19
    v_exp_f32 v20, v20
    v_exp_f32 v21, v21
    s_waitcnt vmcnt(10)
    s_cmp_le_u32 s55, 2
    s_cbranch_scc1 KV_23
    v_mov_b64 v[236:237], 0
    v_mov_b64 v[238:239], 0
    v_mov_b64 v[240:241], 0
    v_mov_b64 v[242:243], 0
    s_nop 1
KV_23:
    v_mfma_f32_32x32x16_bf16 v[32:47], v[248:251], v[120:123], 0
    v_exp_f32 v22, v22
    v_exp_f32 v23, v23
    v_cvt_pk_bf16_f32 v48, v16, v17
    v_cvt_pk_bf16_f32 v49, v18, v19
    v_cvt_pk_bf16_f32 v50, v20, v21
    v_cvt_pk_bf16_f32 v51, v22, v23
    v_exp_f32 v24, v24
    v_exp_f32 v25, v25
    v_mfma_f32_32x32x16_bf16 v[56:71], v[228:231], v[48:51], 0
    s_add_u32 m0, s63, 0
    s_add_u32 s45, s62, 0
    buffer_load_dwordx4 v254, s[12:15], s45 offen lds
    s_add_u32 m0, s63, 1024
    s_add_u32 s45, s62, 8192
    buffer_load_dwordx4 v254, s[12:15], s45 offen lds
    v_exp_f32 v26, v26
    v_exp_f32 v27, v27
    v_exp_f32 v28, v28
    v_exp_f32 v29, v29
    v_exp_f32 v30, v30
    v_exp_f32 v31, v31
    v_cvt_pk_bf16_f32 v52, v24, v25
    v_cvt_pk_bf16_f32 v53, v26, v27
    v_cvt_pk_bf16_f32 v54, v28, v29
    v_cvt_pk_bf16_f32 v55, v30, v31
    v_exp_f32 v32, v32
    v_exp_f32 v33, v33
    v_mfma_f32_32x32x16_bf16 v[56:71], v[232:235], v[52:55], v[56:71]
    v_exp_f32 v34, v34
    v_exp_f32 v35, v35
    v_exp_f32 v36, v36
    v_exp_f32 v37, v37
    s_waitcnt vmcnt(9)
    s_cmp_le_u32 s55, 1
    s_cbranch_scc1 KV_24
    v_mov_b64 v[76:77], 0
    v_mov_b64 v[78:79], 0
    v_mov_b64 v[80:81], 0
    v_mov_b64 v[82:83], 0
    s_nop 1
KV_24:
    v_mfma_f32_32x32x16_bf16 v[16:31], v[72:75], v[120:123], 0
    v_exp_f32 v38, v38
    v_exp_f32 v39, v39
    v_cvt_pk_bf16_f32 v48, v32, v33
    v_cvt_pk_bf16_f32 v49, v34, v35
    v_cvt_pk_bf16_f32 v50, v36, v37
    v_cvt_pk_bf16_f32 v51, v38, v39
    v_exp_f32 v40, v40
    v_exp_f32 v41, v41
    v_mfma_f32_32x32x16_bf16 v[56:71], v[236:239], v[48:51], v[56:71]
    s_add_u32 m0, s63, 2048
    s_add_u32 s45, s62, 16384
    buffer_load_dwordx4 v254, s[12:15], s45 offen lds
    s_add_u32 m0, s63, 3072
    s_add_u32 s45, s62, 24576
    buffer_load_dwordx4 v254, s[12:15], s45 offen lds
    v_exp_f32 v42, v42
    v_exp_f32 v43, v43
    v_exp_f32 v44, v44
    v_exp_f32 v45, v45
    v_exp_f32 v46, v46
    v_exp_f32 v47, v47
    v_cvt_pk_bf16_f32 v52, v40, v41
    v_cvt_pk_bf16_f32 v53, v42, v43
    v_cvt_pk_bf16_f32 v54, v44, v45
    v_cvt_pk_bf16_f32 v55, v46, v47
    v_exp_f32 v16, v16
    v_exp_f32 v17, v17
    v_mfma_f32_32x32x16_bf16 v[56:71], v[240:243], v[52:55], v[56:71]
    v_exp_f32 v18, v18
    v_exp_f32 v19, v19
    v_exp_f32 v20, v20
    v_exp_f32 v21, v21
    s_waitcnt vmcnt(8)
    s_cmp_le_u32 s55, 0
    s_cbranch_scc1 KV_25
    v_mov_b64 v[88:89], 0
    v_mov_b64 v[90:91], 0
    v_mov_b64 v[92:93], 0
    v_mov_b64 v[94:95], 0
    s_nop 1
KV_25:
    v_mfma_f32_32x32x16_bf16 v[32:47], v[84:87], v[120:123], v[212:227]
    v_exp_f32 v22, v22
    v_exp_f32 v23, v23
    v_cvt_pk_bf16_f32 v48, v16, v17
    v_cvt_pk_bf16_f32 v49, v18, v19
    v_cvt_pk_bf16_f32 v50, v20, v21
    v_cvt_pk_bf16_f32 v51, v22, v23
    v_exp_f32 v24, v24
    v_exp_f32 v25, v25
    v_mfma_f32_32x32x16_bf16 v[56:71], v[76:79], v[48:51], v[56:71]
    s_waitcnt vmcnt(4)
    v_mov_b32 v168, s42
    v_mov_b32 v169, s43
    v_mov_b32 v170, 0
    s_mov_b64 exec, 1
    buffer_store_dwordx2 v[168:169], v170, s[28:31], s59 offen sc1
    s_mov_b64 exec, -1
    s_add_u32 m0, s63, 4096
    s_add_u32 s45, s62, 32768
    buffer_load_dwordx4 v254, s[12:15], s45 offen lds
    s_add_u32 m0, s63, 5120
    s_add_u32 s45, s62, 40960
    buffer_load_dwordx4 v254, s[12:15], s45 offen lds
    v_exp_f32 v26, v26
    v_exp_f32 v27, v27
    v_exp_f32 v28, v28
    v_exp_f32 v29, v29
    v_exp_f32 v30, v30
    v_exp_f32 v31, v31
    v_cvt_pk_bf16_f32 v52, v24, v25
    v_cvt_pk_bf16_f32 v53, v26, v27
    v_cvt_pk_bf16_f32 v54, v28, v29
    v_cvt_pk_bf16_f32 v55, v30, v31
    v_exp_f32 v32, v32
    v_exp_f32 v33, v33
    v_mfma_f32_32x32x16_bf16 v[56:71], v[80:83], v[52:55], v[56:71]
    v_exp_f32 v34, v34
    v_exp_f32 v35, v35
    v_exp_f32 v36, v36
    v_exp_f32 v37, v37
    v_mfma_f32_32x32x16_bf16 v[16:31], v[244:247], v[124:127], 0
    v_exp_f32 v38, v38
    v_exp_f32 v39, v39
    v_cvt_pk_bf16_f32 v48, v32, v33
    v_cvt_pk_bf16_f32 v49, v34, v35
    v_cvt_pk_bf16_f32 v50, v36, v37
    v_cvt_pk_bf16_f32 v51, v38, v39
    v_exp_f32 v40, v40
    v_exp_f32 v41, v41
    v_mfma_f32_32x32x16_bf16 v[56:71], v[88:91], v[48:51], v[56:71]
    s_add_u32 m0, s63, 6144
    s_add_u32 s45, s62, 49152
    buffer_load_dwordx4 v254, s[12:15], s45 offen lds
    s_add_u32 m0, s63, 7168
    s_add_u32 s45, s62, 57344
    buffer_load_dwordx4 v254, s[12:15], s45 offen lds
    v_exp_f32 v42, v42
    v_exp_f32 v43, v43
    v_exp_f32 v44, v44
    v_exp_f32 v45, v45
    v_exp_f32 v46, v46
    v_exp_f32 v47, v47
    v_cvt_pk_bf16_f32 v52, v40, v41
    v_cvt_pk_bf16_f32 v53, v42, v43
    v_cvt_pk_bf16_f32 v54, v44, v45
    v_cvt_pk_bf16_f32 v55, v46, v47
    v_exp_f32 v16, v16
    v_exp_f32 v17, v17
    v_mfma_f32_32x32x16_bf16 v[56:71], v[92:95], v[52:55], v[56:71]
    v_exp_f32 v18, v18
    v_exp_f32 v19, v19
    v_exp_f32 v20, v20
    v_exp_f32 v21, v21
    v_mfma_f32_32x32x16_bf16 v[32:47], v[248:251], v[124:127], 0
    v_exp_f32 v22, v22
    v_exp_f32 v23, v23
    v_cvt_pk_bf16_f32 v48, v16, v17
    v_cvt_pk_bf16_f32 v49, v18, v19
    v_cvt_pk_bf16_f32 v50, v20, v21
    v_cvt_pk_bf16_f32 v51, v22, v23
    v_exp_f32 v24, v24
    v_exp_f32 v25, v25
    v_mfma_f32_32x32x16_bf16 v[128:143], v[228:231], v[48:51], 0
    v_lshl_add_u32 v188, v1, 2, v255
    v_mov_b32 v189, 68624
    ds_write_b128 v252, v[56:59] offset:2048
    ds_write_b128 v252, v[60:63] offset:3072
    ds_write_b32 v188, v64 offset:512
    ds_write_b32 v255, v189 offset:8
    v_exp_f32 v26, v26
    v_exp_f32 v27, v27
    v_exp_f32 v28, v28
    v_exp_f32 v29, v29
    v_exp_f32 v30, v30
    v_exp_f32 v31, v31
    v_cvt_pk_bf16_f32 v52, v24, v25
    v_cvt_pk_bf16_f32 v53, v26, v27
    v_cvt_pk_bf16_f32 v54, v28, v29
    v_cvt_pk_bf16_f32 v55, v30, v31
    s_setprio 0
    v_exp_f32 v32, v32
    v_exp_f32 v33, v33
    v_mfma_f32_32x32x16_bf16 v[128:143], v[232:235], v[52:55], v[128:143]
    v_exp_f32 v34, v34
    v_exp_f32 v35, v35
    v_exp_f32 v36, v36
    v_exp_f32 v37, v37
    v_mfma_f32_32x32x16_bf16 v[16:31], v[72:75], v[124:127], v[212:227]
    v_exp_f32 v38, v38
    v_exp_f32 v39, v39
    v_cvt_pk_bf16_f32 v48, v32, v33
    v_cvt_pk_bf16_f32 v49, v34, v35
    v_cvt_pk_bf16_f32 v50, v36, v37
    v_cvt_pk_bf16_f32 v51, v38, v39
    v_exp_f32 v40, v40
    v_exp_f32 v41, v41
    v_mfma_f32_32x32x16_bf16 v[128:143], v[236:239], v[48:51], v[128:143]
    v_exp_f32 v42, v42
    v_exp_f32 v43, v43
    v_exp_f32 v44, v44
    v_exp_f32 v45, v45
    v_exp_f32 v46, v46
    v_exp_f32 v47, v47
    v_cvt_pk_bf16_f32 v52, v40, v41
    v_cvt_pk_bf16_f32 v53, v42, v43
    v_cvt_pk_bf16_f32 v54, v44, v45
    v_cvt_pk_bf16_f32 v55, v46, v47
    v_exp_f32 v16, v16
    v_exp_f32 v17, v17
    v_mfma_f32_32x32x16_bf16 v[128:143], v[240:243], v[52:55], v[128:143]
    v_exp_f32 v18, v18
    v_exp_f32 v19, v19
    v_exp_f32 v20, v20
    v_exp_f32 v21, v21
    v_exp_f32 v22, v22
    v_exp_f32 v23, v23
    v_cvt_pk_bf16_f32 v48, v16, v17
    v_cvt_pk_bf16_f32 v49, v18, v19
    v_cvt_pk_bf16_f32 v50, v20, v21
    v_cvt_pk_bf16_f32 v51, v22, v23
    v_exp_f32 v24, v24
    v_exp_f32 v25, v25
    v_mfma_f32_32x32x16_bf16 v[128:143], v[76:79], v[48:51], v[128:143]
    buffer_load_dwordx2 v[8:9], v209, s[28:31], s24 offen sc1
    buffer_load_dwordx2 v[172:173], v10, s[28:31], s58 offen sc1
    ds_read_b32 v185, v255 offset:4
    ds_read_b32 v184, v188 offset:256
    ds_read_b128 v[176:179], v252 offset:0
    ds_read_b128 v[180:183], v252 offset:1024
    ds_read_b32 v186, v189
    ds_read_b32 v187, v255
    v_exp_f32 v26, v26
    v_exp_f32 v27, v27
    v_exp_f32 v28, v28
    v_exp_f32 v29, v29
    v_exp_f32 v30, v30
    v_exp_f32 v31, v31
    v_cvt_pk_bf16_f32 v52, v24, v25
    v_cvt_pk_bf16_f32 v53, v26, v27
    v_cvt_pk_bf16_f32 v54, v28, v29
    v_cvt_pk_bf16_f32 v55, v30, v31
    s_nop 1
    v_mfma_f32_32x32x16_bf16 v[128:143], v[80:83], v[52:55], v[128:143]
    s_mov_b32 s59, s24
    s_setprio 0
    v_mov_b32 v7, v209
    s_mov_b32 s44, 200000
XW_26:
    s_waitcnt lgkmcnt(0)
    v_readfirstlane_b32 s45, v185
    v_readfirstlane_b32 s48, v187
    v_readfirstlane_b32 s41, v186
    s_min_u32 s45, s45, s48
    s_cmp_ge_u32 s45, 8
    s_cbranch_scc1 XD_27
    ds_read_b32 v185, v255 offset:4
    ds_read_b32 v184, v188 offset:256
    ds_read_b128 v[176:179], v252 offset:0
    ds_read_b128 v[180:183], v252 offset:1024
    ds_read_b32 v186, v189
    ds_read_b32 v187, v255
    s_sub_u32 s44, s44, 1
    s_cbranch_scc0 XW_26
    s_waitcnt lgkmcnt(0)
XD_27:
    s_mov_b32 s45, 0x30800000
    s_mov_b32 s48, 0x4e800000
    v_add_f32 v64, v136, v184
    v_rcp_f32 v66, v64
    v_cmp_nlt_f32 vcc, s45, v64
    v_cmp_ngt_f32 s[50:51], s48, v64
    v_pk_add_f32 v[56:57], v[128:129], v[176:177]
    v_pk_add_f32 v[58:59], v[130:131], v[178:179]
    v_pk_add_f32 v[60:61], v[132:133], v[180:181]
    v_pk_add_f32 v[62:63], v[134:135], v[182:183]
    s_or_b64 vcc, vcc, s[50:51]
    s_cbranch_vccnz L_SLOW
L_ATTNORM1:
    v_pk_mul_f32 v[56:57], v[56:57], v[66:67] op_sel_hi:[1,0]
    v_pk_mul_f32 v[58:59], v[58:59], v[66:67] op_sel_hi:[1,0]
    v_pk_mul_f32 v[60:61], v[60:61], v[66:67] op_sel_hi:[1,0]
    v_pk_mul_f32 v[62:63], v[62:63], v[66:67] op_sel_hi:[1,0]
    v_cvt_pk_bf16_f32 v48, v56, v57
    v_cvt_pk_bf16_f32 v49, v58, v59
    v_cvt_pk_bf16_f32 v50, v60, v61
    v_cvt_pk_bf16_f32 v51, v62, v63
    s_cmp_eq_u32 s41, 0
    s_cbranch_scc1 L_OGLOB1
    buffer_store_dwordx4 v[48:51], v211, s[28:31], s57 offen nt
L_OST1:
    v_add_u32 v19, s92, v211
    v_mov_b32 v16, s42
    v_mov_b32 v17, s43
    v_mov_b32 v18, 0
    ds_write_b128 v19, v[48:51]
    s_waitcnt vmcnt(1)
    v_cmp_ne_u64 vcc, s[42:43], v[172:173]
    s_mov_b32 s91, 0
    s_and_b32 s45, vcc_lo, s76
    s_cbranch_scc1 L_ONOY
    s_mov_b32 s91, 1
    s_mov_b64 exec, s[70:71]
    s_add_u32 m0, s74, 98304
    s_add_u32 s45, s75, 0
    buffer_load_dwordx4 v211, s[28:31], s45 offen offset:0 sc1 lds
    buffer_load_dwordx4 v211, s[28:31], s45 offen offset:1024 sc1 lds
    s_add_u32 m0, s74, 102400
    s_add_u32 s45, s75, 4096
    buffer_load_dwordx4 v211, s[28:31], s45 offen offset:0 sc1 lds
    buffer_load_dwordx4 v211, s[28:31], s45 offen offset:1024 sc1 lds
    s_mov_b64 exec, -1
    s_mov_b64 exec, s[70:71]
    s_add_u32 m0, s74, 100352
    s_add_u32 s45, s75, 2048
    buffer_load_dwordx4 v211, s[28:31], s45 offen offset:0 sc1 lds
    buffer_load_dwordx4 v211, s[28:31], s45 offen offset:1024 sc1 lds
    s_add_u32 m0, s74, 104448
    s_add_u32 s45, s75, 6144
    buffer_load_dwordx4 v211, s[28:31], s45 offen offset:0 sc1 lds
    buffer_load_dwordx4 v211, s[28:31], s45 offen offset:1024 sc1 lds
    s_mov_b64 exec, -1
    s_waitcnt vmcnt(8)
    s_branch L_OFL
L_ONOY:
    s_waitcnt vmcnt(0)
L_OFL:
    s_mov_b64 exec, 1
    s_cmp_eq_u32 s41, 0
    s_cbranch_scc1 L_FGLOB1
    buffer_store_dwordx2 v[16:17], v18, s[28:31], s93 offen
L_ODONE1:
    s_mov_b64 exec, -1
    s_waitcnt lgkmcnt(0)
    s_barrier
    s_cmp_lg_u32 s91, 0
    s_cbranch_scc1 L_OREST
    s_mov_b32 s44, 200000
FP_28:
    buffer_load_dwordx2 v[172:173], v10, s[28:31], s58 offen sc1
    s_waitcnt vmcnt(0)
    v_cmp_ne_u64 vcc, s[42:43], v[172:173]
    s_sub_u32 s44, s44, 1
    s_cbranch_scc1 FPD_29
    s_and_b32 s45, vcc_lo, s76
    s_cbranch_scc1 FP_28
FPD_29:
    s_mov_b64 exec, s[70:71]
    s_add_u32 m0, s74, 98304
    s_add_u32 s45, s75, 0
    buffer_load_dwordx4 v211, s[28:31], s45 offen offset:0 sc1 lds
    buffer_load_dwordx4 v211, s[28:31], s45 offen offset:1024 sc1 lds
    s_add_u32 m0, s74, 102400
    s_add_u32 s45, s75, 4096
    buffer_load_dwordx4 v211, s[28:31], s45 offen offset:0 sc1 lds
    buffer_load_dwordx4 v211, s[28:31], s45 offen offset:1024 sc1 lds
    s_mov_b64 exec, -1
    s_mov_b64 exec, s[70:71]
    s_add_u32 m0, s74, 100352
    s_add_u32 s45, s75, 2048
    buffer_load_dwordx4 v211, s[28:31], s45 offen offset:0 sc1 lds
    buffer_load_dwordx4 v211, s[28:31], s45 offen offset:1024 sc1 lds
    s_add_u32 m0, s74, 104448
    s_add_u32 s45, s75, 6144
    buffer_load_dwordx4 v211, s[28:31], s45 offen offset:0 sc1 lds
    buffer_load_dwordx4 v211, s[28:31], s45 offen offset:1024 sc1 lds
    s_mov_b64 exec, -1
L_OREST:
    s_and_b32 s45, vcc_lo, s77
    s_cbranch_scc1 L_BLATE
L_BOK:
    s_mov_b64 exec, s[72:73]
    s_add_u32 m0, s74, 106496
    s_add_u32 s45, s75, 8192
    buffer_load_dwordx4 v211, s[28:31], s45 offen offset:0 sc1 lds
    buffer_load_dwordx4 v211, s[28:31], s45 offen offset:1024 sc1 lds
    s_add_u32 m0, s74, 110592
    s_add_u32 s45, s75, 12288
    buffer_load_dwordx4 v211, s[28:31], s45 offen offset:0 sc1 lds
    buffer_load_dwordx4 v211, s[28:31], s45 offen offset:1024 sc1 lds
    s_mov_b64 exec, -1
    s_mov_b64 exec, s[72:73]
    s_add_u32 m0, s74, 108544
    s_add_u32 s45, s75, 10240
    buffer_load_dwordx4 v211, s[28:31], s45 offen offset:0 sc1 lds
    buffer_load_dwordx4 v211, s[28:31], s45 offen offset:1024 sc1 lds
    s_add_u32 m0, s74, 112640
    s_add_u32 s45, s75, 14336
    buffer_load_dwordx4 v211, s[28:31], s45 offen offset:0 sc1 lds
    buffer_load_dwordx4 v211, s[28:31], s45 offen offset:1024 sc1 lds
    s_mov_b64 exec, -1
    s_waitcnt vmcnt(12)
    s_barrier
    v_cmp_ne_u64 s[50:51], s[42:43], v[8:9]
    s_mov_b32 s91, 0
    s_cmp_lg_u64 s[50:51], 0
    s_cbranch_scc1 YT_30
    s_add_u32 m0, s22, 65536
    s_add_u32 s45, s25, 32768
    buffer_load_dwordx4 v200, s[28:31], s25 offen sc1 lds
    s_add_u32 m0, s22, 66560
    s_nop 0
    buffer_load_dwordx4 v200, s[28:31], s45 offen sc1 lds
    s_mov_b32 s91, 1
YT_30:
    s_cmp_eq_u32 s91, 0
    s_cbranch_scc1 L_NY
    s_waitcnt vmcnt(10)
    s_barrier
    s_waitcnt vmcnt(6)
    s_barrier
    s_waitcnt vmcnt(2)
    s_barrier
L_YJOIN:
    s_waitcnt vmcnt(0)
    s_barrier
L_FIN:
L_END:
    s_endpgm
L_NY:
    buffer_load_dwordx2 v[8:9], v7, s[28:31], s59 offen sc1
    s_waitcnt vmcnt(9)
    s_barrier
    s_waitcnt vmcnt(5)
    s_barrier
    s_waitcnt vmcnt(1)
    s_barrier
    s_waitcnt vmcnt(0)
L_YLATE:
    s_mov_b32 s44, 200000
    s_branch POLLC_33
POLL_31:
    buffer_load_dwordx2 v[8:9], v7, s[28:31], s59 offen sc1
    s_waitcnt vmcnt(0)
POLLC_33:
    v_cmp_ne_u64 vcc, s[42:43], v[8:9]
    s_sub_u32 s44, s44, 1
    s_cbranch_scc1 POLLD_32
    s_cbranch_vccnz POLL_31
POLLD_32:
    s_add_u32 m0, s22, 65536
    s_add_u32 s45, s25, 32768
    buffer_load_dwordx4 v200, s[28:31], s25 offen sc1 lds
    s_add_u32 m0, s22, 66560
    s_nop 0
    buffer_load_dwordx4 v200, s[28:31], s45 offen sc1 lds
    s_branch L_YJOIN
L_BLATE:
    buffer_load_dwordx2 v[172:173], v10, s[28:31], s58 offen sc1
    s_waitcnt vmcnt(0)
    v_cmp_ne_u64 vcc, s[42:43], v[172:173]
    s_nop 0
    s_and_b32 s45, vcc_lo, s77
    s_cbranch_scc0 L_BOK
    buffer_load_dwordx2 v[172:173], v10, s[28:31], s58 offen sc1
    s_waitcnt vmcnt(0)
    v_cmp_ne_u64 vcc, s[42:43], v[172:173]
    s_nop 0
    s_and_b32 s45, vcc_lo, s77
    s_cbranch_scc0 L_BOK
    s_waitcnt vmcnt(4)
    s_barrier
    s_waitcnt vmcnt(0)
    s_barrier
    s_mov_b32 s44, 200000
FP_34:
    buffer_load_dwordx2 v[172:173], v10, s[28:31], s58 offen sc1
    s_waitcnt vmcnt(0)
    v_cmp_ne_u64 vcc, s[42:43], v[172:173]
    s_sub_u32 s44, s44, 1
    s_cbranch_scc1 FPD_35
    s_and_b32 s45, vcc_lo, s77
    s_cbranch_scc1 FP_34
FPD_35:
    s_mov_b64 exec, s[72:73]
    s_add_u32 m0, s74, 106496
    s_add_u32 s45, s75, 8192
    buffer_load_dwordx4 v211, s[28:31], s45 offen offset:0 sc1 lds
    buffer_load_dwordx4 v211, s[28:31], s45 offen offset:1024 sc1 lds
    s_add_u32 m0, s74, 110592
    s_add_u32 s45, s75, 12288
    buffer_load_dwordx4 v211, s[28:31], s45 offen offset:0 sc1 lds
    buffer_load_dwordx4 v211, s[28:31], s45 offen offset:1024 sc1 lds
    s_mov_b64 exec, -1
    s_mov_b64 exec, s[72:73]
    s_add_u32 m0, s74, 108544
    s_add_u32 s45, s75, 10240
    buffer_load_dwordx4 v211, s[28:31], s45 offen offset:0 sc1 lds
    buffer_load_dwordx4 v211, s[28:31], s45 offen offset:1024 sc1 lds
    s_add_u32 m0, s74, 112640
    s_add_u32 s45, s75, 14336
    buffer_load_dwordx4 v211, s[28:31], s45 offen offset:0 sc1 lds
    buffer_load_dwordx4 v211, s[28:31], s45 offen offset:1024 sc1 lds
    s_mov_b64 exec, -1
    v_cmp_ne_u64 s[50:51], s[42:43], v[8:9]
    s_mov_b32 s91, 0
    s_cmp_lg_u64 s[50:51], 0
    s_cbranch_scc1 YT_36
    s_add_u32 m0, s22, 65536
    s_add_u32 s45, s25, 32768
    buffer_load_dwordx4 v200, s[28:31], s25 offen sc1 lds
    s_add_u32 m0, s22, 66560
    s_nop 0
    buffer_load_dwordx4 v200, s[28:31], s45 offen sc1 lds
    s_mov_b32 s91, 1
YT_36:
    s_cmp_eq_u32 s91, 0
    s_cbranch_scc1 L_NY2
    s_waitcnt vmcnt(6)
    s_barrier
    s_waitcnt vmcnt(2)
    s_barrier
    s_branch L_YJOIN
L_NY2:
    buffer_load_dwordx2 v[8:9], v7, s[28:31], s59 offen sc1
    s_waitcnt vmcnt(5)
    s_barrier
    s_waitcnt vmcnt(1)
    s_barrier
    s_waitcnt vmcnt(0)
    s_branch L_YLATE
L_OGLOB0:
    buffer_store_dwordx4 v[48:51], v211, s[28:31], s57 offen sc1
    s_branch L_OST0
L_FGLOB0:
    buffer_store_dwordx2 v[16:17], v18, s[28:31], s93 offen sc1
    s_branch L_ODONE0
L_OGLOB1:
    buffer_store_dwordx4 v[48:51], v211, s[28:31], s57 offen sc1
    s_branch L_OST1
L_FGLOB1:
    buffer_store_dwordx2 v[16:17], v18, s[28:31], s93 offen sc1
    s_branch L_ODONE1
L_SLOW:
    s_waitcnt vmcnt(0)
    v_mov_b32 v104, 0
    v_mov_b32 v105, 0xff800000
    s_mov_b32 s48, 0xffffffff
    s_mov_b32 s49, 0xfffffff0
    v_cndmask_b32 v72, v105, v104, s[48:49]
    s_mov_b32 s50, 0xfffffffe
    s_mov_b32 s51, 0xffffffe0
    v_cndmask_b32 v73, v105, v104, s[50:51]
    s_mov_b32 s48, 0xfffffffc
    s_mov_b32 s49, 0xffffffc0
    v_cndmask_b32 v74, v105, v104, s[48:49]
    s_mov_b32 s50, 0xfffffff8
    s_mov_b32 s51, 0xffffff80
    v_cndmask_b32 v75, v105, v104, s[50:51]
    s_mov_b32 s48, 0xffffff00
    s_mov_b32 s49, 0xfffff000
    v_cndmask_b32 v76, v105, v104, s[48:49]
    s_mov_b32 s50, 0xfffffe00
    s_mov_b32 s51, 0xffffe000
    v_cndmask_b32 v77, v105, v104, s[50:51]
    s_mov_b32 s48, 0xfffffc00
    s_mov_b32 s49, 0xffffc000
    v_cndmask_b32 v78, v105, v104, s[48:49]
    s_mov_b32 s50, 0xfffff800
    s_mov_b32 s51, 0xffff8000
    v_cndmask_b32 v79, v105, v104, s[50:51]
    s_mov_b32 s48, 0xffff0000
    s_mov_b32 s49, 0xfff00000
    v_cndmask_b32 v80, v105, v104, s[48:49]
    s_mov_b32 s50, 0xfffe0000
    s_mov_b32 s51, 0xffe00000
    v_cndmask_b32 v81, v105, v104, s[50:51]
    s_mov_b32 s48, 0xfffc0000
    s_mov_b32 s49, 0xffc00000
    v_cndmask_b32 v82, v105, v104, s[48:49]
    s_mov_b32 s50, 0xfff80000
    s_mov_b32 s51, 0xff800000
    v_cndmask_b32 v83, v105, v104, s[50:51]
    s_mov_b32 s48, 0xff000000
    s_mov_b32 s49, 0xf0000000
    v_cndmask_b32 v84, v105, v104, s[48:49]
    s_mov_b32 s50, 0xfe000000
    s_mov_b32 s51, 0xe0000000
    v_cndmask_b32 v85, v105, v104, s[50:51]
    s_mov_b32 s48, 0xfc000000
    s_mov_b32 s49, 0xc0000000
    v_cndmask_b32 v86, v105, v104, s[48:49]
    s_mov_b32 s50, 0xf8000000
    s_mov_b32 s51, 0x80000000
    v_cndmask_b32 v87, v105, v104, s[50:51]
    v_mov_b32 v104, 0
    v_mov_b32 v105, 0xff800000
    s_mov_b32 s48, 0xffffffff
    s_mov_b32 s49, 0xfffffff0
    v_cndmask_b32 v88, v104, v105, s[48:49]
    s_mov_b32 s50, 0xfffffffe
    s_mov_b32 s51, 0xffffffe0
    v_cndmask_b32 v89, v104, v105, s[50:51]
    s_mov_b32 s48, 0xfffffffc
    s_mov_b32 s49, 0xffffffc0
    v_cndmask_b32 v90, v104, v105, s[48:49]
    s_mov_b32 s50, 0xfffffff8
    s_mov_b32 s51, 0xffffff80
    v_cndmask_b32 v91, v104, v105, s[50:51]
    s_mov_b32 s48, 0xffffff00
    s_mov_b32 s49, 0xfffff000
    v_cndmask_b32 v92, v104, v105, s[48:49]
    s_mov_b32 s50, 0xfffffe00
    s_mov_b32 s51, 0xffffe000
    v_cndmask_b32 v93, v104, v105, s[50:51]
    s_mov_b32 s48, 0xfffffc00
    s_mov_b32 s49, 0xffffc000
    v_cndmask_b32 v94, v104, v105, s[48:49]
    s_mov_b32 s50, 0xfffff800
    s_mov_b32 s51, 0xffff8000
    v_cndmask_b32 v95, v104, v105, s[50:51]
    s_mov_b32 s48, 0xffff0000
    s_mov_b32 s49, 0xfff00000
    v_cndmask_b32 v96, v104, v105, s[48:49]
    s_mov_b32 s50, 0xfffe0000
    s_mov_b32 s51, 0xffe00000
    v_cndmask_b32 v97, v104, v105, s[50:51]
    s_mov_b32 s48, 0xfffc0000
    s_mov_b32 s49, 0xffc00000
    v_cndmask_b32 v98, v104, v105, s[48:49]
    s_mov_b32 s50, 0xfff80000
    s_mov_b32 s51, 0xff800000
    v_cndmask_b32 v99, v104, v105, s[50:51]
    s_mov_b32 s48, 0xff000000
    s_mov_b32 s49, 0xf0000000
    v_cndmask_b32 v100, v104, v105, s[48:49]
    s_mov_b32 s50, 0xfe000000
    s_mov_b32 s51, 0xe0000000
    v_cndmask_b32 v101, v104, v105, s[50:51]
    s_mov_b32 s48, 0xfc000000
    s_mov_b32 s49, 0xc0000000
    v_cndmask_b32 v102, v104, v105, s[48:49]
    s_mov_b32 s50, 0xf8000000
    s_mov_b32 s51, 0x80000000
    v_cndmask_b32 v103, v104, v105, s[50:51]
    s_mov_b32 s48, 0x110000
    s_mov_b32 s49, 0x110000
    v_mov_b32 v229, 0x3f803f80
    v_cndmask_b32 v228, 0, v229, s[48:49]
    v_mov_b32 v229, v228
    v_mov_b64 v[230:231], v[228:229]
    v_mov_b64 v[232:233], v[228:229]
    v_mov_b64 v[234:235], v[228:229]
    s_cmp_eq_u32 s54, 0
    s_cselect_b64 vcc, -1, 0
    s_lshl_b32 s49, s37, 1
    s_add_u32 s49, s49, s54
    s_add_u32 s49, s49, 1
    s_min_u32 s49, s49, 9
    s_lshl_b32 s48, s54, 13
    s_add_u32 s48, s48, s94
    v_mov_b32 v106, 0xff800000
    v_cndmask_b32 v120, v124, v120, vcc
    v_cndmask_b32 v121, v125, v121, vcc
    v_cndmask_b32 v122, v126, v122, vcc
    v_cndmask_b32 v123, v127, v123, vcc
    s_sub_u32 s45, s48, 0
    buffer_load_dwordx4 v[244:247], v211, s[28:31], s45 offen sc1
    s_waitcnt vmcnt(0)
    v_mfma_f32_32x32x16_bf16 v[16:31], v[244:247], v[120:123], v[72:87]
    s_nop 11
    v_max3_f32 v106, v16, v17, v106
    v_max3_f32 v106, v18, v19, v106
    v_max3_f32 v106, v20, v21, v106
    v_max3_f32 v106, v22, v23, v106
    v_max3_f32 v106, v24, v25, v106
    v_max3_f32 v106, v26, v27, v106
    v_max3_f32 v106, v28, v29, v106
    v_max3_f32 v106, v30, v31, v106
    s_cmp_eq_u32 s49, 1
    s_cbranch_scc1 L_SLOW2
    s_sub_u32 s45, s48, 8192
    buffer_load_dwordx4 v[244:247], v211, s[28:31], s45 offen sc1
    s_waitcnt vmcnt(0)
    v_mfma_f32_32x32x16_bf16 v[16:31], v[244:247], v[120:123], 0
    s_nop 11
    v_max3_f32 v106, v16, v17, v106
    v_max3_f32 v106, v18, v19, v106
    v_max3_f32 v106, v20, v21, v106
    v_max3_f32 v106, v22, v23, v106
    v_max3_f32 v106, v24, v25, v106
    v_max3_f32 v106, v26, v27, v106
    v_max3_f32 v106, v28, v29, v106
    v_max3_f32 v106, v30, v31, v106
    s_cmp_eq_u32 s49, 2
    s_cbranch_scc1 L_SLOW2
    s_sub_u32 s45, s48, 16384
    buffer_load_dwordx4 v[244:247], v211, s[28:31], s45 offen sc1
    s_waitcnt vmcnt(0)
    v_mfma_f32_32x32x16_bf16 v[16:31], v[244:247], v[120:123], 0
    s_nop 11
    v_max3_f32 v106, v16, v17, v106
    v_max3_f32 v106, v18, v19, v106
    v_max3_f32 v106, v20, v21, v106
    v_max3_f32 v106, v22, v23, v106
    v_max3_f32 v106, v24, v25, v106
    v_max3_f32 v106, v26, v27, v106
    v_max3_f32 v106, v28, v29, v106
    v_max3_f32 v106, v30, v31, v106
    s_cmp_eq_u32 s49, 3
    s_cbranch_scc1 L_SLOW2
    s_sub_u32 s45, s48, 24576
    buffer_load_dwordx4 v[244:247], v211, s[28:31], s45 offen sc1
    s_waitcnt vmcnt(0)
    v_mfma_f32_32x32x16_bf16 v[16:31], v[244:247], v[120:123], 0
    s_nop 11
    v_max3_f32 v106, v16, v17, v106
    v_max3_f32 v106, v18, v19, v106
    v_max3_f32 v106, v20, v21, v106
    v_max3_f32 v106, v22, v23, v106
    v_max3_f32 v106, v24, v25, v106
    v_max3_f32 v106, v26, v27, v106
    v_max3_f32 v106, v28, v29, v106
    v_max3_f32 v106, v30, v31, v106
    s_cmp_eq_u32 s49, 4
    s_cbranch_scc1 L_SLOW2
    s_sub_u32 s45, s48, 32768
    buffer_load_dwordx4 v[244:247], v211, s[28:31], s45 offen sc1
    s_waitcnt vmcnt(0)
    v_mfma_f32_32x32x16_bf16 v[16:31], v[244:247], v[120:123], 0
    s_nop 11
    v_max3_f32 v106, v16, v17, v106
    v_max3_f32 v106, v18, v19, v106
    v_max3_f32 v106, v20, v21, v106
    v_max3_f32 v106, v22, v23, v106
    v_max3_f32 v106, v24, v25, v106
    v_max3_f32 v106, v26, v27, v106
    v_max3_f32 v106, v28, v29, v106
    v_max3_f32 v106, v30, v31, v106
    s_cmp_eq_u32 s49, 5
    s_cbranch_scc1 L_SLOW2
    s_sub_u32 s45, s48, 40960
    buffer_load_dwordx4 v[244:247], v211, s[28:31], s45 offen sc1
    s_waitcnt vmcnt(0)
    v_mfma_f32_32x32x16_bf16 v[16:31], v[244:247], v[120:123], 0
    s_nop 11
    v_max3_f32 v106, v16, v17, v106
    v_max3_f32 v106, v18, v19, v106
    v_max3_f32 v106, v20, v21, v106
    v_max3_f32 v106, v22, v23, v106
    v_max3_f32 v106, v24, v25, v106
    v_max3_f32 v106, v26, v27, v106
    v_max3_f32 v106, v28, v29, v106
    v_max3_f32 v106, v30, v31, v106
    s_cmp_eq_u32 s49, 6
    s_cbranch_scc1 L_SLOW2
    s_sub_u32 s45, s48, 49152
    buffer_load_dwordx4 v[244:247], v211, s[28:31], s45 offen sc1
    s_waitcnt vmcnt(0)
    v_mfma_f32_32x32x16_bf16 v[16:31], v[244:247], v[120:123], 0
    s_nop 11
    v_max3_f32 v106, v16, v17, v106
    v_max3_f32 v106, v18, v19, v106
    v_max3_f32 v106, v20, v21, v106
    v_max3_f32 v106, v22, v23, v106
    v_max3_f32 v106, v24, v25, v106
    v_max3_f32 v106, v26, v27, v106
    v_max3_f32 v106, v28, v29, v106
    v_max3_f32 v106, v30, v31, v106
    s_cmp_eq_u32 s49, 7
    s_cbranch_scc1 L_SLOW2
    s_sub_u32 s45, s48, 57344
    buffer_load_dwordx4 v[244:247], v211, s[28:31], s45 offen sc1
    s_waitcnt vmcnt(0)
    v_mfma_f32_32x32x16_bf16 v[16:31], v[244:247], v[120:123], 0
    s_nop 11
    v_max3_f32 v106, v16, v17, v106
    v_max3_f32 v106, v18, v19, v106
    v_max3_f32 v106, v20, v21, v106
    v_max3_f32 v106, v22, v23, v106
    v_max3_f32 v106, v24, v25, v106
    v_max3_f32 v106, v26, v27, v106
    v_max3_f32 v106, v28, v29, v106
    v_max3_f32 v106, v30, v31, v106
    s_cmp_eq_u32 s49, 8
    s_cbranch_scc1 L_SLOW2
    s_sub_u32 s45, s48, 65536
    buffer_load_dwordx4 v[244:247], v211, s[28:31], s45 offen sc1
    s_waitcnt vmcnt(0)
    v_mfma_f32_32x32x16_bf16 v[16:31], v[244:247], v[120:123], v[88:103]
    s_nop 11
    v_max3_f32 v106, v16, v17, v106
    v_max3_f32 v106, v18, v19, v106
    v_max3_f32 v106, v20, v21, v106
    v_max3_f32 v106, v22, v23, v106
    v_max3_f32 v106, v24, v25, v106
    v_max3_f32 v106, v26, v27, v106
    v_max3_f32 v106, v28, v29, v106
    v_max3_f32 v106, v30, v31, v106
L_SLOW2:
    v_mov_b32 v107, v106
    s_nop 1
    v_permlane32_swap_b32 v106, v107
    v_max_f32 v106, v106, v107
    s_sub_u32 s45, s48, 0
    buffer_load_dwordx4 v[244:247], v211, s[28:31], s45 offen sc1
    s_mov_b64 exec, s[60:61]
    buffer_load_dwordx4 v[228:231], v253, s[28:31], s45 offen sc1
    buffer_load_dwordx4 v[232:235], v253, s[28:31], s45 offen offset:512 sc1
    s_mov_b64 exec, -1
    s_waitcnt vmcnt(0)
    v_mfma_f32_32x32x16_bf16 v[16:31], v[244:247], v[120:123], v[72:87]
    s_nop 11
    v_sub_f32 v16, v16, v106
    v_sub_f32 v17, v17, v106
    v_sub_f32 v18, v18, v106
    v_sub_f32 v19, v19, v106
    v_sub_f32 v20, v20, v106
    v_sub_f32 v21, v21, v106
    v_sub_f32 v22, v22, v106
    v_sub_f32 v23, v23, v106
    v_sub_f32 v24, v24, v106
    v_sub_f32 v25, v25, v106
    v_sub_f32 v26, v26, v106
    v_sub_f32 v27, v27, v106
    v_sub_f32 v28, v28, v106
    v_sub_f32 v29, v29, v106
    v_sub_f32 v30, v30, v106
    v_sub_f32 v31, v31, v106
    v_exp_f32 v16, v16
    v_exp_f32 v17, v17
    v_exp_f32 v18, v18
    v_exp_f32 v19, v19
    v_exp_f32 v20, v20
    v_exp_f32 v21, v21
    v_exp_f32 v22, v22
    v_exp_f32 v23, v23
    v_exp_f32 v24, v24
    v_exp_f32 v25, v25
    v_exp_f32 v26, v26
    v_exp_f32 v27, v27
    v_exp_f32 v28, v28
    v_exp_f32 v29, v29
    v_exp_f32 v30, v30
    v_exp_f32 v31, v31
    v_cvt_pk_bf16_f32 v48, v16, v17
    v_cvt_pk_bf16_f32 v49, v18, v19
    v_cvt_pk_bf16_f32 v50, v20, v21
    v_cvt_pk_bf16_f32 v51, v22, v23
    v_cvt_pk_bf16_f32 v52, v24, v25
    v_cvt_pk_bf16_f32 v53, v26, v27
    v_cvt_pk_bf16_f32 v54, v28, v29
    v_cvt_pk_bf16_f32 v55, v30, v31
    v_mfma_f32_32x32x16_bf16 v[56:71], v[228:231], v[48:51], 0
    s_nop 0
    v_mfma_f32_32x32x16_bf16 v[56:71], v[232:235], v[52:55], v[56:71]
    s_cmp_eq_u32 s49, 1
    s_cbranch_scc1 L_SLOW3
    s_sub_u32 s45, s48, 8192
    buffer_load_dwordx4 v[244:247], v211, s[28:31], s45 offen sc1
    s_mov_b64 exec, s[60:61]
    buffer_load_dwordx4 v[228:231], v253, s[28:31], s45 offen sc1
    buffer_load_dwordx4 v[232:235], v253, s[28:31], s45 offen offset:512 sc1
    s_mov_b64 exec, -1
    s_waitcnt vmcnt(0)
    v_mfma_f32_32x32x16_bf16 v[16:31], v[244:247], v[120:123], 0
    s_nop 11
    v_sub_f32 v16, v16, v106
    v_sub_f32 v17, v17, v106
    v_sub_f32 v18, v18, v106
    v_sub_f32 v19, v19, v106
    v_sub_f32 v20, v20, v106
    v_sub_f32 v21, v21, v106
    v_sub_f32 v22, v22, v106
    v_sub_f32 v23, v23, v106
    v_sub_f32 v24, v24, v106
    v_sub_f32 v25, v25, v106
    v_sub_f32 v26, v26, v106
    v_sub_f32 v27, v27, v106
    v_sub_f32 v28, v28, v106
    v_sub_f32 v29, v29, v106
    v_sub_f32 v30, v30, v106
    v_sub_f32 v31, v31, v106
    v_exp_f32 v16, v16
    v_exp_f32 v17, v17
    v_exp_f32 v18, v18
    v_exp_f32 v19, v19
    v_exp_f32 v20, v20
    v_exp_f32 v21, v21
    v_exp_f32 v22, v22
    v_exp_f32 v23, v23
    v_exp_f32 v24, v24
    v_exp_f32 v25, v25
    v_exp_f32 v26, v26
    v_exp_f32 v27, v27
    v_exp_f32 v28, v28
    v_exp_f32 v29, v29
    v_exp_f32 v30, v30
    v_exp_f32 v31, v31
    v_cvt_pk_bf16_f32 v48, v16, v17
    v_cvt_pk_bf16_f32 v49, v18, v19
    v_cvt_pk_bf16_f32 v50, v20, v21
    v_cvt_pk_bf16_f32 v51, v22, v23
    v_cvt_pk_bf16_f32 v52, v24, v25
    v_cvt_pk_bf16_f32 v53, v26, v27
    v_cvt_pk_bf16_f32 v54, v28, v29
    v_cvt_pk_bf16_f32 v55, v30, v31
    v_mfma_f32_32x32x16_bf16 v[56:71], v[228:231], v[48:51], v[56:71]
    s_nop 0
    v_mfma_f32_32x32x16_bf16 v[56:71], v[232:235], v[52:55], v[56:71]
    s_cmp_eq_u32 s49, 2
    s_cbranch_scc1 L_SLOW3
    s_sub_u32 s45, s48, 16384
    buffer_load_dwordx4 v[244:247], v211, s[28:31], s45 offen sc1
    s_mov_b64 exec, s[60:61]
    buffer_load_dwordx4 v[228:231], v253, s[28:31], s45 offen sc1
    buffer_load_dwordx4 v[232:235], v253, s[28:31], s45 offen offset:512 sc1
    s_mov_b64 exec, -1
    s_waitcnt vmcnt(0)
    v_mfma_f32_32x32x16_bf16 v[16:31], v[244:247], v[120:123], 0
    s_nop 11
    v_sub_f32 v16, v16, v106
    v_sub_f32 v17, v17, v106
    v_sub_f32 v18, v18, v106
    v_sub_f32 v19, v19, v106
    v_sub_f32 v20, v20, v106
    v_sub_f32 v21, v21, v106
    v_sub_f32 v22, v22, v106
    v_sub_f32 v23, v23, v106
    v_sub_f32 v24, v24, v106
    v_sub_f32 v25, v25, v106
    v_sub_f32 v26, v26, v106
    v_sub_f32 v27, v27, v106
    v_sub_f32 v28, v28, v106
    v_sub_f32 v29, v29, v106
    v_sub_f32 v30, v30, v106
    v_sub_f32 v31, v31, v106
    v_exp_f32 v16, v16
    v_exp_f32 v17, v17
    v_exp_f32 v18, v18
    v_exp_f32 v19, v19
    v_exp_f32 v20, v20
    v_exp_f32 v21, v21
    v_exp_f32 v22, v22
    v_exp_f32 v23, v23
    v_exp_f32 v24, v24
    v_exp_f32 v25, v25
    v_exp_f32 v26, v26
    v_exp_f32 v27, v27
    v_exp_f32 v28, v28
    v_exp_f32 v29, v29
    v_exp_f32 v30, v30
    v_exp_f32 v31, v31
    v_cvt_pk_bf16_f32 v48, v16, v17
    v_cvt_pk_bf16_f32 v49, v18, v19
    v_cvt_pk_bf16_f32 v50, v20, v21
    v_cvt_pk_bf16_f32 v51, v22, v23
    v_cvt_pk_bf16_f32 v52, v24, v25
    v_cvt_pk_bf16_f32 v53, v26, v27
    v_cvt_pk_bf16_f32 v54, v28, v29
    v_cvt_pk_bf16_f32 v55, v30, v31
    v_mfma_f32_32x32x16_bf16 v[56:71], v[228:231], v[48:51], v[56:71]
    s_nop 0
    v_mfma_f32_32x32x16_bf16 v[56:71], v[232:235], v[52:55], v[56:71]
    s_cmp_eq_u32 s49, 3
    s_cbranch_scc1 L_SLOW3
    s_sub_u32 s45, s48, 24576
    buffer_load_dwordx4 v[244:247], v211, s[28:31], s45 offen sc1
    s_mov_b64 exec, s[60:61]
    buffer_load_dwordx4 v[228:231], v253, s[28:31], s45 offen sc1
    buffer_load_dwordx4 v[232:235], v253, s[28:31], s45 offen offset:512 sc1
    s_mov_b64 exec, -1
    s_waitcnt vmcnt(0)
    v_mfma_f32_32x32x16_bf16 v[16:31], v[244:247], v[120:123], 0
    s_nop 11
    v_sub_f32 v16, v16, v106
    v_sub_f32 v17, v17, v106
    v_sub_f32 v18, v18, v106
    v_sub_f32 v19, v19, v106
    v_sub_f32 v20, v20, v106
    v_sub_f32 v21, v21, v106
    v_sub_f32 v22, v22, v106
    v_sub_f32 v23, v23, v106
    v_sub_f32 v24, v24, v106
    v_sub_f32 v25, v25, v106
    v_sub_f32 v26, v26, v106
    v_sub_f32 v27, v27, v106
    v_sub_f32 v28, v28, v106
    v_sub_f32 v29, v29, v106
    v_sub_f32 v30, v30, v106
    v_sub_f32 v31, v31, v106
    v_exp_f32 v16, v16
    v_exp_f32 v17, v17
    v_exp_f32 v18, v18
    v_exp_f32 v19, v19
    v_exp_f32 v20, v20
    v_exp_f32 v21, v21
    v_exp_f32 v22, v22
    v_exp_f32 v23, v23
    v_exp_f32 v24, v24
    v_exp_f32 v25, v25
    v_exp_f32 v26, v26
    v_exp_f32 v27, v27
    v_exp_f32 v28, v28
    v_exp_f32 v29, v29
    v_exp_f32 v30, v30
    v_exp_f32 v31, v31
    v_cvt_pk_bf16_f32 v48, v16, v17
    v_cvt_pk_bf16_f32 v49, v18, v19
    v_cvt_pk_bf16_f32 v50, v20, v21
    v_cvt_pk_bf16_f32 v51, v22, v23
    v_cvt_pk_bf16_f32 v52, v24, v25
    v_cvt_pk_bf16_f32 v53, v26, v27
    v_cvt_pk_bf16_f32 v54, v28, v29
    v_cvt_pk_bf16_f32 v55, v30, v31
    v_mfma_f32_32x32x16_bf16 v[56:71], v[228:231], v[48:51], v[56:71]
    s_nop 0
    v_mfma_f32_32x32x16_bf16 v[56:71], v[232:235], v[52:55], v[56:71]
    s_cmp_eq_u32 s49, 4
    s_cbranch_scc1 L_SLOW3
    s_sub_u32 s45, s48, 32768
    buffer_load_dwordx4 v[244:247], v211, s[28:31], s45 offen sc1
    s_mov_b64 exec, s[60:61]
    buffer_load_dwordx4 v[228:231], v253, s[28:31], s45 offen sc1
    buffer_load_dwordx4 v[232:235], v253, s[28:31], s45 offen offset:512 sc1
    s_mov_b64 exec, -1
    s_waitcnt vmcnt(0)
    v_mfma_f32_32x32x16_bf16 v[16:31], v[244:247], v[120:123], 0
    s_nop 11
    v_sub_f32 v16, v16, v106
    v_sub_f32 v17, v17, v106
    v_sub_f32 v18, v18, v106
    v_sub_f32 v19, v19, v106
    v_sub_f32 v20, v20, v106
    v_sub_f32 v21, v21, v106
    v_sub_f32 v22, v22, v106
    v_sub_f32 v23, v23, v106
    v_sub_f32 v24, v24, v106
    v_sub_f32 v25, v25, v106
    v_sub_f32 v26, v26, v106
    v_sub_f32 v27, v27, v106
    v_sub_f32 v28, v28, v106
    v_sub_f32 v29, v29, v106
    v_sub_f32 v30, v30, v106
    v_sub_f32 v31, v31, v106
    v_exp_f32 v16, v16
    v_exp_f32 v17, v17
    v_exp_f32 v18, v18
    v_exp_f32 v19, v19
    v_exp_f32 v20, v20
    v_exp_f32 v21, v21
    v_exp_f32 v22, v22
    v_exp_f32 v23, v23
    v_exp_f32 v24, v24
    v_exp_f32 v25, v25
    v_exp_f32 v26, v26
    v_exp_f32 v27, v27
    v_exp_f32 v28, v28
    v_exp_f32 v29, v29
    v_exp_f32 v30, v30
    v_exp_f32 v31, v31
    v_cvt_pk_bf16_f32 v48, v16, v17
    v_cvt_pk_bf16_f32 v49, v18, v19
    v_cvt_pk_bf16_f32 v50, v20, v21
    v_cvt_pk_bf16_f32 v51, v22, v23
    v_cvt_pk_bf16_f32 v52, v24, v25
    v_cvt_pk_bf16_f32 v53, v26, v27
    v_cvt_pk_bf16_f32 v54, v28, v29
    v_cvt_pk_bf16_f32 v55, v30, v31
    v_mfma_f32_32x32x16_bf16 v[56:71], v[228:231], v[48:51], v[56:71]
    s_nop 0
    v_mfma_f32_32x32x16_bf16 v[56:71], v[232:235], v[52:55], v[56:71]
    s_cmp_eq_u32 s49, 5
    s_cbranch_scc1 L_SLOW3
    s_sub_u32 s45, s48, 40960
    buffer_load_dwordx4 v[244:247], v211, s[28:31], s45 offen sc1
    s_mov_b64 exec, s[60:61]
    buffer_load_dwordx4 v[228:231], v253, s[28:31], s45 offen sc1
    buffer_load_dwordx4 v[232:235], v253, s[28:31], s45 offen offset:512 sc1
    s_mov_b64 exec, -1
    s_waitcnt vmcnt(0)
    v_mfma_f32_32x32x16_bf16 v[16:31], v[244:247], v[120:123], 0
    s_nop 11
    v_sub_f32 v16, v16, v106
    v_sub_f32 v17, v17, v106
    v_sub_f32 v18, v18, v106
    v_sub_f32 v19, v19, v106
    v_sub_f32 v20, v20, v106
    v_sub_f32 v21, v21, v106
    v_sub_f32 v22, v22, v106
    v_sub_f32 v23, v23, v106
    v_sub_f32 v24, v24, v106
    v_sub_f32 v25, v25, v106
    v_sub_f32 v26, v26, v106
    v_sub_f32 v27, v27, v106
    v_sub_f32 v28, v28, v106
    v_sub_f32 v29, v29, v106
    v_sub_f32 v30, v30, v106
    v_sub_f32 v31, v31, v106
    v_exp_f32 v16, v16
    v_exp_f32 v17, v17
    v_exp_f32 v18, v18
    v_exp_f32 v19, v19
    v_exp_f32 v20, v20
    v_exp_f32 v21, v21
    v_exp_f32 v22, v22
    v_exp_f32 v23, v23
    v_exp_f32 v24, v24
    v_exp_f32 v25, v25
    v_exp_f32 v26, v26
    v_exp_f32 v27, v27
    v_exp_f32 v28, v28
    v_exp_f32 v29, v29
    v_exp_f32 v30, v30
    v_exp_f32 v31, v31
    v_cvt_pk_bf16_f32 v48, v16, v17
    v_cvt_pk_bf16_f32 v49, v18, v19
    v_cvt_pk_bf16_f32 v50, v20, v21
    v_cvt_pk_bf16_f32 v51, v22, v23
    v_cvt_pk_bf16_f32 v52, v24, v25
    v_cvt_pk_bf16_f32 v53, v26, v27
    v_cvt_pk_bf16_f32 v54, v28, v29
    v_cvt_pk_bf16_f32 v55, v30, v31
    v_mfma_f32_32x32x16_bf16 v[56:71], v[228:231], v[48:51], v[56:71]
    s_nop 0
    v_mfma_f32_32x32x16_bf16 v[56:71], v[232:235], v[52:55], v[56:71]
    s_cmp_eq_u32 s49, 6
    s_cbranch_scc1 L_SLOW3
    s_sub_u32 s45, s48, 49152
    buffer_load_dwordx4 v[244:247], v211, s[28:31], s45 offen sc1
    s_mov_b64 exec, s[60:61]
    buffer_load_dwordx4 v[228:231], v253, s[28:31], s45 offen sc1
    buffer_load_dwordx4 v[232:235], v253, s[28:31], s45 offen offset:512 sc1
    s_mov_b64 exec, -1
    s_waitcnt vmcnt(0)
    v_mfma_f32_32x32x16_bf16 v[16:31], v[244:247], v[120:123], 0
    s_nop 11
    v_sub_f32 v16, v16, v106
    v_sub_f32 v17, v17, v106
    v_sub_f32 v18, v18, v106
    v_sub_f32 v19, v19, v106
    v_sub_f32 v20, v20, v106
    v_sub_f32 v21, v21, v106
    v_sub_f32 v22, v22, v106
    v_sub_f32 v23, v23, v106
    v_sub_f32 v24, v24, v106
    v_sub_f32 v25, v25, v106
    v_sub_f32 v26, v26, v106
    v_sub_f32 v27, v27, v106
    v_sub_f32 v28, v28, v106
    v_sub_f32 v29, v29, v106
    v_sub_f32 v30, v30, v106
    v_sub_f32 v31, v31, v106
    v_exp_f32 v16, v16
    v_exp_f32 v17, v17
    v_exp_f32 v18, v18
    v_exp_f32 v19, v19
    v_exp_f32 v20, v20
    v_exp_f32 v21, v21
    v_exp_f32 v22, v22
    v_exp_f32 v23, v23
    v_exp_f32 v24, v24
    v_exp_f32 v25, v25
    v_exp_f32 v26, v26
    v_exp_f32 v27, v27
    v_exp_f32 v28, v28
    v_exp_f32 v29, v29
    v_exp_f32 v30, v30
    v_exp_f32 v31, v31
    v_cvt_pk_bf16_f32 v48, v16, v17
    v_cvt_pk_bf16_f32 v49, v18, v19
    v_cvt_pk_bf16_f32 v50, v20, v21
    v_cvt_pk_bf16_f32 v51, v22, v23
    v_cvt_pk_bf16_f32 v52, v24, v25
    v_cvt_pk_bf16_f32 v53, v26, v27
    v_cvt_pk_bf16_f32 v54, v28, v29
    v_cvt_pk_bf16_f32 v55, v30, v31
    v_mfma_f32_32x32x16_bf16 v[56:71], v[228:231], v[48:51], v[56:71]
    s_nop 0
    v_mfma_f32_32x32x16_bf16 v[56:71], v[232:235], v[52:55], v[56:71]
    s_cmp_eq_u32 s49, 7
    s_cbranch_scc1 L_SLOW3
    s_sub_u32 s45, s48, 57344
    buffer_load_dwordx4 v[244:247], v211, s[28:31], s45 offen sc1
    s_mov_b64 exec, s[60:61]
    buffer_load_dwordx4 v[228:231], v253, s[28:31], s45 offen sc1
    buffer_load_dwordx4 v[232:235], v253, s[28:31], s45 offen offset:512 sc1
    s_mov_b64 exec, -1
    s_waitcnt vmcnt(0)
    v_mfma_f32_32x32x16_bf16 v[16:31], v[244:247], v[120:123], 0
    s_nop 11
    v_sub_f32 v16, v16, v106
    v_sub_f32 v17, v17, v106
    v_sub_f32 v18, v18, v106
    v_sub_f32 v19, v19, v106
    v_sub_f32 v20, v20, v106
    v_sub_f32 v21, v21, v106
    v_sub_f32 v22, v22, v106
    v_sub_f32 v23, v23, v106
    v_sub_f32 v24, v24, v106
    v_sub_f32 v25, v25, v106
    v_sub_f32 v26, v26, v106
    v_sub_f32 v27, v27, v106
    v_sub_f32 v28, v28, v106
    v_sub_f32 v29, v29, v106
    v_sub_f32 v30, v30, v106
    v_sub_f32 v31, v31, v106
    v_exp_f32 v16, v16
    v_exp_f32 v17, v17
    v_exp_f32 v18, v18
    v_exp_f32 v19, v19
    v_exp_f32 v20, v20
    v_exp_f32 v21, v21
    v_exp_f32 v22, v22
    v_exp_f32 v23, v23
    v_exp_f32 v24, v24
    v_exp_f32 v25, v25
    v_exp_f32 v26, v26
    v_exp_f32 v27, v27
    v_exp_f32 v28, v28
    v_exp_f32 v29, v29
    v_exp_f32 v30, v30
    v_exp_f32 v31, v31
    v_cvt_pk_bf16_f32 v48, v16, v17
    v_cvt_pk_bf16_f32 v49, v18, v19
    v_cvt_pk_bf16_f32 v50, v20, v21
    v_cvt_pk_bf16_f32 v51, v22, v23
    v_cvt_pk_bf16_f32 v52, v24, v25
    v_cvt_pk_bf16_f32 v53, v26, v27
    v_cvt_pk_bf16_f32 v54, v28, v29
    v_cvt_pk_bf16_f32 v55, v30, v31
    v_mfma_f32_32x32x16_bf16 v[56:71], v[228:231], v[48:51], v[56:71]
    s_nop 0
    v_mfma_f32_32x32x16_bf16 v[56:71], v[232:235], v[52:55], v[56:71]
    s_cmp_eq_u32 s49, 8
    s_cbranch_scc1 L_SLOW3
    s_sub_u32 s45, s48, 65536
    buffer_load_dwordx4 v[244:247], v211, s[28:31], s45 offen sc1
    s_mov_b64 exec, s[60:61]
    buffer_load_dwordx4 v[228:231], v253, s[28:31], s45 offen sc1
    buffer_load_dwordx4 v[232:235], v253, s[28:31], s45 offen offset:512 sc1
    s_mov_b64 exec, -1
    s_waitcnt vmcnt(0)
    v_mfma_f32_32x32x16_bf16 v[16:31], v[244:247], v[120:123], v[88:103]
    s_nop 11
    v_sub_f32 v16, v16, v106
    v_sub_f32 v17, v17, v106
    v_sub_f32 v18, v18, v106
    v_sub_f32 v19, v19, v106
    v_sub_f32 v20, v20, v106
    v_sub_f32 v21, v21, v106
    v_sub_f32 v22, v22, v106
    v_sub_f32 v23, v23, v106
    v_sub_f32 v24, v24, v106
    v_sub_f32 v25, v25, v106
    v_sub_f32 v26, v26, v106
    v_sub_f32 v27, v27, v106
    v_sub_f32 v28, v28, v106
    v_sub_f32 v29, v29, v106
    v_sub_f32 v30, v30, v106
    v_sub_f32 v31, v31, v106
    v_exp_f32 v16, v16
    v_exp_f32 v17, v17
    v_exp_f32 v18, v18
    v_exp_f32 v19, v19
    v_exp_f32 v20, v20
    v_exp_f32 v21, v21
    v_exp_f32 v22, v22
    v_exp_f32 v23, v23
    v_exp_f32 v24, v24
    v_exp_f32 v25, v25
    v_exp_f32 v26, v26
    v_exp_f32 v27, v27
    v_exp_f32 v28, v28
    v_exp_f32 v29, v29
    v_exp_f32 v30, v30
    v_exp_f32 v31, v31
    v_cvt_pk_bf16_f32 v48, v16, v17
    v_cvt_pk_bf16_f32 v49, v18, v19
    v_cvt_pk_bf16_f32 v50, v20, v21
    v_cvt_pk_bf16_f32 v51, v22, v23
    v_cvt_pk_bf16_f32 v52, v24, v25
    v_cvt_pk_bf16_f32 v53, v26, v27
    v_cvt_pk_bf16_f32 v54, v28, v29
    v_cvt_pk_bf16_f32 v55, v30, v31
    v_mfma_f32_32x32x16_bf16 v[56:71], v[228:231], v[48:51], v[56:71]
    s_nop 0
    v_mfma_f32_32x32x16_bf16 v[56:71], v[232:235], v[52:55], v[56:71]
L_SLOW3:
    s_nop 11
    v_rcp_f32 v66, v64
    s_cmp_lt_u32 s36, 4
    s_cbranch_scc1 L_ATTNORM0
    s_branch L_ATTNORM1

.section .rodata,"a"
.p2align 6
.amdhsa_kernel gated_mix__sliding_block__ssm_conv_h3__prompt_kernel
  .amdhsa_next_free_vgpr 256
  .amdhsa_next_free_sgpr 102
  .amdhsa_accum_offset 256
  .amdhsa_group_segment_fixed_size 0
  .amdhsa_kernarg_size 104
  .amdhsa_user_sgpr_count 2
  .amdhsa_user_sgpr_kernarg_segment_ptr 1
  .amdhsa_system_sgpr_workgroup_id_x 1
.end_amdhsa_kernel
```
